```python
import torch

def _softmax(x, axis=-1):
    return torch.softmax(x, dim=axis)
def _gelu(x):
    return torch.nn.functional.gelu(x, approximate="tanh")
def _silu(x):
    return torch.nn.functional.silu(x)
def _sigmoid(x):
    return torch.sigmoid(x)
def _layernorm(x, axis=-1, eps=1e-5):
    m = x.mean(dim=axis, keepdim=True)
    v = x.var(dim=axis, keepdim=True, unbiased=False)
    return (x - m) / torch.sqrt(v + eps)
def _scatter_add(tgt, idx, src, axis=0):
    return tgt.clone().index_add_(axis, idx, src)
def _segment_sum(src, seg, n):
    out = torch.zeros((n,) + src.shape[1:], dtype=src.dtype)
    return out.index_add_(0, seg, src)
def _pad(x, pw):
    flat = tuple(v for pair in reversed(pw) for v in pair)
    return torch.nn.functional.pad(x, flat)

kernel_name = 'concat_heads__ssm_conv_s5__mha_block__prompt'

def setup_inputs():

    _w = (lambda a: (lambda t: t.to(torch.bfloat16) if t.is_floating_point() else t)(torch.as_tensor(a)))
    def _A_setup():
        B, S, D = 1, 2048, 512
        P = D
        Lambda_re = -0.5 * (lambda _x: torch.exp(torch.as_tensor(_x)))((lambda *s: torch.randn(*s, dtype=torch.bfloat16) * 0.4)(P))
        Lambda_im = (lambda *s: torch.randn(*s, dtype=torch.bfloat16) * 0.8)(P) * 1.0
        B_re = (lambda *s: torch.randn(*s, dtype=torch.bfloat16) * 0.8)(P, D) * (D ** -0.5)
        B_im = (lambda *s: torch.randn(*s, dtype=torch.bfloat16) * 0.8)(P, D) * (D ** -0.5)
        C_re = (lambda *s: torch.randn(*s, dtype=torch.bfloat16) * 0.4)(D, P) * (P ** -0.5)
        C_im = (lambda *s: torch.randn(*s, dtype=torch.bfloat16) * 0.8)(D, P) * (P ** -0.5)
        log_dt = (lambda *s: torch.randn(*s, dtype=torch.bfloat16) * 0.4)(P) * 0.3 - 2.0
        Dskip = (lambda *s: torch.randn(*s, dtype=torch.bfloat16) * 0.1)(D)
        return {
            "x": _w((lambda *s: torch.randn(*s, dtype=torch.bfloat16) * 0.05)(B, S, D)),
            "Lambda_re": _w(Lambda_re),
            "Lambda_im": _w(Lambda_im),
            "B_re": _w(B_re),
            "B_im": _w(B_im),
            "C_re": _w(C_re),
            "C_im": _w(C_im),
            "log_dt": _w(log_dt),
            "Dskip": _w(Dskip),
        }
    _A_in = _A_setup()

    def _B_setup():
        B, S, D, H = 1, 2048, 512, 32
        return {
            "x": _w((lambda *s: torch.randn(*s, dtype=torch.bfloat16) * 0.2)(B, S, D)),
            "wqkv": _w((lambda *s: torch.randn(*s, dtype=torch.bfloat16) * 0.2)(D, 3 * D)),
            "wo": _w((lambda *s: torch.randn(*s, dtype=torch.bfloat16) * 0.05)(D, D)),
        }
    _B_in = _B_setup()

    return {
        "A_x": _A_in["x"],
        "A_Lambda_re": _A_in["Lambda_re"],
        "A_Lambda_im": _A_in["Lambda_im"],
        "A_B_re": _A_in["B_re"],
        "A_B_im": _A_in["B_im"],
        "A_C_re": _A_in["C_re"],
        "A_C_im": _A_in["C_im"],
        "A_log_dt": _A_in["log_dt"],
        "A_Dskip": _A_in["Dskip"],
        "B_x": _B_in["x"],
        "B_wqkv": _B_in["wqkv"],
        "B_wo": _B_in["wo"],
    }

def reference(A_x, A_Lambda_re, A_Lambda_im, A_B_re, A_B_im, A_C_re, A_C_im, A_log_dt, A_Dskip, B_x, B_wqkv, B_wo):
    def _A_ref(x, Lambda_re, Lambda_im, B_re, B_im, C_re, C_im, log_dt, Dskip):
        Bsz, L, H = x.shape
        Lam = Lambda_re + 1j * Lambda_im
        Bmat = B_re + 1j * B_im
        Cmat = C_re + 1j * C_im
        dt = torch.exp(log_dt)
        Lam_bar = torch.exp(dt * Lam)
        B_bar = ((Lam_bar - 1.0) / Lam)[:, None] * Bmat
        Bu = torch.einsum("bld,pd->blp", x + 0j, B_bar)
        h = torch.zeros_like(Bu[:, 0, :])
        hs = []
        for t in range(L):
            h = Lam_bar[None, :] * h + Bu[:, t, :]
            hs.append(h)
        hseq = torch.stack(hs, 1)
        y = 2.0 * torch.einsum("blp,dp->bld", hseq, Cmat).real + x * Dskip[None, None, :]
        return y

    def _B_ref(x, wqkv, wo):
        B, S, D = x.shape
        H = 32
        Dh = D // H
        qkv = (lambda x, *d: x.permute(*d))((x @ wqkv).reshape(B, S, 3, H, Dh), 2, 0, 3, 1, 4)
        q, k, v = qkv[0], qkv[1], qkv[2]
        scores = torch.einsum("bhqd,bhkd->bhqk", q, k) * (Dh ** -0.5)
        p = _softmax(scores, axis=-1)
        o = torch.einsum("bhqk,bhkd->bhqd", p, v)
        return (lambda x, *d: x.permute(*d))(o, 0, 2, 1, 3).reshape(B, S, D) @ wo

    a = _A_ref(A_x, A_Lambda_re, A_Lambda_im, A_B_re, A_B_im, A_C_re, A_C_im, A_log_dt, A_Dskip)
    b = _B_ref(B_x, B_wqkv, B_wo)
    return torch.concatenate([a, b], axis=-1)
```

```asm
; @launch grid=(256,1,1) block=(768,1,1) lds=160064
.amdgcn_target "amdgcn-amd-amdhsa--gfx950"
.text
.globl concat_heads__ssm_conv_s5__mha_block__prompt_kernel
.p2align 8
.type concat_heads__ssm_conv_s5__mha_block__prompt_kernel,@function
concat_heads__ssm_conv_s5__mha_block__prompt_kernel:
    s_load_dwordx4 s[40:43], s[0:1], 72
    s_load_dwordx2 s[4:5], s[0:1], 112
    v_lshrrev_b32 v1, 6, v0
    v_and_b32 v0, 63, v0
    v_readfirstlane_b32 s20, v1
    s_cmp_ge_u32 s2, 256
    s_cbranch_scc1 L_end
    s_getreg_b32 s30, hwreg(HW_REG_XCC_ID, 0, 3)
    s_lshr_b32 s31, s2, 3
    v_lshlrev_b32 v1, 4, v0
    s_cmp_lt_u32 s20, 8
    s_cbranch_scc1 L_a
    s_sub_u32 s20, s20, 8
L_s0:
    v_lshrrev_b32 v8, 2, v0
    v_mul_u32_u24 v8, 3072, v8
    v_and_b32 v9, 3, v0
    v_lshl_add_u32 v166, v9, 4, v8
    s_and_b32 s35, s31, 15
    s_lshl_b32 s35, s35, 2
    s_add_u32 s35, s35, s20
    s_and_b32 s21, s31, 15
    s_lshr_b32 s33, s31, 4
    s_lshl_b32 s22, s33, 3
    s_add_u32 s22, s22, s30
    s_lshl_b32 s33, s33, 2
    s_add_u32 s23, s21, s33
    s_add_u32 s23, s21, s30
    s_mul_i32 s98, s20, 49152
    s_lshl_b32 s33, s22, 6
    s_add_u32 s98, s98, s33
    s_mul_i32 s100, s20, 3072
    s_add_u32 s100, s100, 16384
    s_lshl_b32 s97, s35, 15
    s_lshl_b32 s99, s20, 12
    s_mov_b32 s96, s23
    v_lshrrev_b32 v8, 3, v0
    v_lshlrev_b32 v8, 10, v8
    v_and_b32 v9, 7, v0
    v_lshrrev_b32 v10, 4, v0
    v_xor_b32 v9, v9, v10
    v_lshl_add_u32 v162, v9, 4, v8
    v_xor_b32 v163, 64, v162
    v_add_u32 v164, 14336, v162
    v_add_u32 v165, 21504, v163
    v_add_u32 v163, 7168, v163
    s_waitcnt lgkmcnt(0)
    s_mov_b32 s48, s42
    s_mov_b32 s49, s43
    s_mov_b32 s50, 0x180000
    s_mov_b32 s51, 0x00020000
    s_mov_b32 s44, s40
    s_mov_b32 s45, s41
    s_mov_b32 s46, 0x200000
    s_mov_b32 s47, 0x00020000
    s_and_b32 s96, s96, 7
    s_add_u32 m0, s100, 0
    s_mul_i32 s33, s96, 196608
    s_add_u32 s33, s33, s98
    buffer_load_dwordx4 v166, s[48:51], s33 offen offset:0  lds
    buffer_load_dwordx4 v166, s[48:51], s33 offen offset:1024  lds
    buffer_load_dwordx4 v166, s[48:51], s33 offen offset:2048  lds
    s_add_u32 m0, s99, 0
    s_lshl_b32 s33, s96, 7
    s_add_u32 s33, s33, s97
    buffer_load_dwordx4 v162, s[44:47], s33 offen offset:0  lds
    buffer_load_dwordx4 v163, s[44:47], s33 offen offset:1024  lds
    buffer_load_dwordx4 v164, s[44:47], s33 offen offset:2048  lds
    buffer_load_dwordx4 v165, s[44:47], s33 offen offset:3072  lds
    s_add_u32 s96, s96, 1
    s_lshl_b32 s101, s22, 17
    s_lshl_b32 s33, s35, 10
    s_add_u32 s101, s101, s33
    s_load_dwordx8 s[52:59], s[0:1], 0
    s_load_dwordx2 s[60:61], s[0:1], 32
    s_load_dwordx4 s[24:27], s[0:1], 56
    s_and_b32 s96, s96, 7
    s_add_u32 m0, s100, 28672
    s_mul_i32 s33, s96, 196608
    s_add_u32 s33, s33, s98
    buffer_load_dwordx4 v166, s[48:51], s33 offen offset:0  lds
    buffer_load_dwordx4 v166, s[48:51], s33 offen offset:1024  lds
    buffer_load_dwordx4 v166, s[48:51], s33 offen offset:2048  lds
    s_add_u32 m0, s99, 28672
    s_lshl_b32 s33, s96, 7
    s_add_u32 s33, s33, s97
    buffer_load_dwordx4 v162, s[44:47], s33 offen offset:0  lds
    buffer_load_dwordx4 v163, s[44:47], s33 offen offset:1024  lds
    buffer_load_dwordx4 v164, s[44:47], s33 offen offset:2048  lds
    buffer_load_dwordx4 v165, s[44:47], s33 offen offset:3072  lds
    s_add_u32 s96, s96, 1
    s_lshl_b32 s21, s30, 1
    s_lshr_b32 s33, s31, 4
    s_add_u32 s21, s21, s33
    s_and_b32 s22, s31, 15
    s_add_u32 s23, s22, s30
    s_mov_b32 s23, s30
    s_lshr_b32 s28, s31, 2
    s_and_b32 s33, s31, 3
    s_lshl_b32 s29, s30, 2
    s_add_u32 s29, s29, s33
    s_lshr_b32 s33, s20, 1
    s_lshl_b32 s34, s29, 1
    s_add_u32 s33, s33, s34
    s_and_b32 s34, s20, 1
    s_lshl_b32 s35, s28, 1
    s_add_u32 s34, s34, s35
    s_lshl_b32 s37, s33, 17
    s_lshl_b32 s35, s34, 7
    s_add_u32 s37, s37, s35
    s_lshl_b32 s38, s33, 15
    s_lshl_b32 s35, s34, 6
    s_add_u32 s38, s38, s35
    v_and_b32 v19, 31, v0
    v_lshrrev_b32 v20, 5, v0
    v_lshl_add_u32 v7, v19, 1, s35
    s_lshl_b32 s33, s22, 6
    v_lshl_add_u32 v8, v19, 1, s33
    s_waitcnt lgkmcnt(0)
    global_load_ushort v16, v8, s[54:55]
    global_load_ushort v17, v8, s[56:57]
    global_load_ushort v18, v8, s[24:25]
    global_load_ushort v21, v7, s[26:27]
    s_mov_b32 s8, s4
    s_mov_b32 s9, s5
    s_mov_b32 s10, 0x1000000
    s_mov_b32 s11, 0x00020000
    s_mov_b32 s3, 13119488
    s_load_dword s7, s[4:5], s3
    s_mov_b32 s12, s52
    s_mov_b32 s13, s53
    s_mov_b32 s14, 0x200000
    s_mov_b32 s15, 0x00020000
    s_cmp_lt_u32 s20, 2
    s_cselect_b64 s[16:17], s[58:59], s[60:61]
    s_mov_b32 s18, 524288
    s_mov_b32 s19, 0x00020000
    s_load_dwordx4 s[56:59], s[0:1], 40
    s_load_dwordx4 s[60:63], s[0:1], 88
    s_mov_b32 s27, s29
    s_lshl_b32 s24, s21, 2
    s_add_u32 s24, s24, s20
    s_mov_b32 s29, s24
    s_lshl_b32 s24, s24, 15
    s_lshl_b32 s25, s22, 1
    s_and_b32 s34, s20, 1
    s_add_u32 s25, s25, s34
    s_lshl_b32 s25, s25, 14
    s_mul_i32 s26, s20, 18432
    s_add_u32 s26, s26, 86016
    s_lshl_b32 s36, s28, 16
    s_lshl_b32 s34, s20, 8
    s_add_u32 s36, s36, s34
    s_lshl_b32 s54, s20, 12
    s_add_u32 s54, s54, 86016
    s_lshl_b32 s55, s20, 11
    s_add_u32 s55, s55, 102400
    v_and_b32 v22, 7, v0
    v_lshrrev_b32 v23, 4, v0
    v_xor_b32 v22, v22, v23
    v_lshlrev_b32 v22, 4, v22
    v_lshrrev_b32 v23, 3, v0
    v_lshl_add_u32 v148, v23, 10, v22
    v_xor_b32 v149, 64, v148
    v_add_u32 v149, 7168, v149
    v_bfe_u32 v23, v0, 3, 1
    v_lshlrev_b32 v23, 3, v23
    v_bfe_u32 v24, v0, 4, 1
    v_add_u32 v23, v23, v24
    v_lshl_add_u32 v23, v20, 4, v23
    v_lshl_add_u32 v144, v23, 10, v22
    v_xor_b32 v24, 64, v144
    v_add_u32 v145, 1024, v24
    v_add_u32 v146, 2048, v144
    v_add_u32 v147, 3072, v24
    v_bfe_u32 v22, v0, 1, 3
    v_xor_b32 v22, v22, v20
    v_lshlrev_b32 v22, 4, v22
    v_lshl_add_u32 v22, v19, 7, v22
    v_xor_b32 v23, 0, v22
    v_add_u32 v136, s54, v23
    v_add_u32 v140, 102400, v23
    v_xor_b32 v23, 32, v22
    v_add_u32 v137, s54, v23
    v_add_u32 v141, 102400, v23
    v_xor_b32 v23, 64, v22
    v_add_u32 v138, s54, v23
    v_add_u32 v142, 102400, v23
    v_xor_b32 v23, 96, v22
    v_add_u32 v139, s54, v23
    v_add_u32 v143, 102400, v23
    v_and_b32 v22, 3, v0
    v_mov_b32 v2, v148
    v_mov_b32 v3, v149
    v_bfe_u32 v24, v0, 2, 2
    v_lshlrev_b32 v23, 4, v20
    v_lshl_add_u32 v6, v19, 10, v23
    s_add_u32 s34, s26, 16384
    v_lshlrev_b32 v23, 5, v20
    v_lshl_add_u32 v23, v19, 6, v23
    v_add_u32 v154, s34, v23
    v_lshl_add_u32 v23, v20, 3, v24
    v_lshlrev_b32 v23, 6, v23
    v_bfe_u32 v24, v0, 4, 1
    v_lshl_add_u32 v23, v24, 5, v23
    v_lshl_add_u32 v23, v22, 3, v23
    v_add_u32 v155, s34, v23
    s_lshl_b32 s34, s20, 9
    s_add_u32 s34, s34, 83712
    v_lshl_add_u32 v150, v0, 3, s34
    s_lshl_b32 s34, s20, 1
    v_add_u32 v22, s34, v20
    v_lshlrev_b32 v23, 3, v19
    v_add_u32 v153, 159744, v23
    v_lshl_add_u32 v23, v22, 8, v23
    v_add_u32 v151, 81920, v23
    v_lshlrev_b32 v152, 4, v19
    v_lshlrev_b32 v4, 2, v19
    v_lshlrev_b32 v22, 4, v22
    v_cvt_f32_u32 v22, v22
    v_mov_b32 v159, v22
    v_lshlrev_b32 v23, 7, v0
    s_lshl_b32 s34, s31, 1
    s_and_b32 s35, s20, 1
    s_add_u32 s34, s34, s35
    s_lshl_b32 s34, s34, 13
    v_add_u32 v157, s34, v23
    s_lshl_b32 s34, s31, 14
    s_lshl_b32 s35, s35, 13
    s_add_u32 s34, s34, s35
    v_add_u32 v158, s34, v23
    v_mov_b32 v167, 1
    s_waitcnt vmcnt(11)
    s_barrier
    s_and_b32 s96, s96, 7
    s_add_u32 m0, s100, 57344
    s_mul_i32 s33, s96, 196608
    s_add_u32 s33, s33, s98
    buffer_load_dwordx4 v166, s[48:51], s33 offen offset:0  lds
    buffer_load_dwordx4 v166, s[48:51], s33 offen offset:1024  lds
    buffer_load_dwordx4 v166, s[48:51], s33 offen offset:2048  lds
    s_add_u32 m0, s99, 57344
    s_lshl_b32 s33, s96, 7
    s_add_u32 s33, s33, s97
    buffer_load_dwordx4 v162, s[44:47], s33 offen offset:0  lds
    buffer_load_dwordx4 v163, s[44:47], s33 offen offset:1024  lds
    buffer_load_dwordx4 v164, s[44:47], s33 offen offset:2048  lds
    buffer_load_dwordx4 v165, s[44:47], s33 offen offset:3072  lds
    s_add_u32 s96, s96, 1
    s_and_b32 s96, s96, 7
    s_add_u32 m0, s100, 86016
    s_mul_i32 s33, s96, 196608
    s_add_u32 s33, s33, s98
    buffer_load_dwordx4 v166, s[48:51], s33 offen offset:0  lds
    buffer_load_dwordx4 v166, s[48:51], s33 offen offset:1024  lds
    buffer_load_dwordx4 v166, s[48:51], s33 offen offset:2048  lds
    s_add_u32 m0, s99, 86016
    s_lshl_b32 s33, s96, 7
    s_add_u32 s33, s33, s97
    buffer_load_dwordx4 v162, s[44:47], s33 offen offset:0  lds
    buffer_load_dwordx4 v163, s[44:47], s33 offen offset:1024  lds
    buffer_load_dwordx4 v164, s[44:47], s33 offen offset:2048  lds
    buffer_load_dwordx4 v165, s[44:47], s33 offen offset:3072  lds
    s_add_u32 s96, s96, 1
    s_waitcnt vmcnt(18)
    s_barrier
    s_and_b32 s96, s96, 7
    s_add_u32 m0, s100, 114688
    s_mul_i32 s33, s96, 196608
    s_add_u32 s33, s33, s98
    buffer_load_dwordx4 v166, s[48:51], s33 offen offset:0  lds
    buffer_load_dwordx4 v166, s[48:51], s33 offen offset:1024  lds
    buffer_load_dwordx4 v166, s[48:51], s33 offen offset:2048  lds
    s_add_u32 m0, s99, 114688
    s_lshl_b32 s33, s96, 7
    s_add_u32 s33, s33, s97
    buffer_load_dwordx4 v162, s[44:47], s33 offen offset:0  lds
    buffer_load_dwordx4 v163, s[44:47], s33 offen offset:1024  lds
    buffer_load_dwordx4 v164, s[44:47], s33 offen offset:2048  lds
    buffer_load_dwordx4 v165, s[44:47], s33 offen offset:3072  lds
    s_add_u32 s96, s96, 1
    s_waitcnt vmcnt(14)
    s_barrier
    s_and_b32 s96, s96, 7
    s_add_u32 m0, s100, 0
    s_mul_i32 s33, s96, 196608
    s_add_u32 s33, s33, s98
    buffer_load_dwordx4 v166, s[48:51], s33 offen offset:0  lds
    buffer_load_dwordx4 v166, s[48:51], s33 offen offset:1024  lds
    buffer_load_dwordx4 v166, s[48:51], s33 offen offset:2048  lds
    s_add_u32 m0, s99, 0
    s_lshl_b32 s33, s96, 7
    s_add_u32 s33, s33, s97
    buffer_load_dwordx4 v162, s[44:47], s33 offen offset:0  lds
    buffer_load_dwordx4 v163, s[44:47], s33 offen offset:1024  lds
    buffer_load_dwordx4 v164, s[44:47], s33 offen offset:2048  lds
    buffer_load_dwordx4 v165, s[44:47], s33 offen offset:3072  lds
    s_add_u32 s96, s96, 1
    s_waitcnt vmcnt(14)
    s_barrier
    s_and_b32 s96, s96, 7
    s_add_u32 m0, s100, 28672
    s_mul_i32 s33, s96, 196608
    s_add_u32 s33, s33, s98
    buffer_load_dwordx4 v166, s[48:51], s33 offen offset:0  lds
    buffer_load_dwordx4 v166, s[48:51], s33 offen offset:1024  lds
    buffer_load_dwordx4 v166, s[48:51], s33 offen offset:2048  lds
    s_add_u32 m0, s99, 28672
    s_lshl_b32 s33, s96, 7
    s_add_u32 s33, s33, s97
    buffer_load_dwordx4 v162, s[44:47], s33 offen offset:0  lds
    buffer_load_dwordx4 v163, s[44:47], s33 offen offset:1024  lds
    buffer_load_dwordx4 v164, s[44:47], s33 offen offset:2048  lds
    buffer_load_dwordx4 v165, s[44:47], s33 offen offset:3072  lds
    s_add_u32 s96, s96, 1
    s_waitcnt vmcnt(14)
    s_barrier
    s_and_b32 s96, s96, 7
    s_add_u32 m0, s100, 57344
    s_mul_i32 s33, s96, 196608
    s_add_u32 s33, s33, s98
    buffer_load_dwordx4 v166, s[48:51], s33 offen offset:0  lds
    buffer_load_dwordx4 v166, s[48:51], s33 offen offset:1024  lds
    buffer_load_dwordx4 v166, s[48:51], s33 offen offset:2048  lds
    s_add_u32 m0, s99, 57344
    s_lshl_b32 s33, s96, 7
    s_add_u32 s33, s33, s97
    buffer_load_dwordx4 v162, s[44:47], s33 offen offset:0  lds
    buffer_load_dwordx4 v163, s[44:47], s33 offen offset:1024  lds
    buffer_load_dwordx4 v164, s[44:47], s33 offen offset:2048  lds
    buffer_load_dwordx4 v165, s[44:47], s33 offen offset:3072  lds
    s_add_u32 s96, s96, 1
    s_waitcnt vmcnt(14)
    s_waitcnt lgkmcnt(0)
    s_barrier
    s_waitcnt vmcnt(7)
    s_barrier
    v_lshrrev_b32 v8, 4, v0
    v_lshlrev_b32 v8, 21, v8
    v_bfe_u32 v9, v0, 3, 1
    v_lshl_add_u32 v8, v9, 16, v8
    v_and_b32 v9, 7, v0
    v_lshl_add_u32 v8, v9, 7, v8
    s_mov_b32 exec_hi, 0xffff
    buffer_load_dword v9, v8, s[8:11], s101 offen sc1
    s_mov_b32 exec_hi, -1
    s_waitcnt vmcnt(1)
    s_barrier
    s_barrier
    v_mov_b32 v10, 160048
    ds_read_b32 v11, v10
    s_waitcnt lgkmcnt(0)
    v_readfirstlane_b32 s33, v11
    s_cmp_eq_u32 s33, s31
    s_cbranch_scc1 L_s1
    s_mov_b32 s31, s33
    s_waitcnt vmcnt(0) lgkmcnt(0)
    s_barrier
    s_branch L_s0
L_s1:
    s_waitcnt vmcnt(0)
    v_mov_b64 v[24:25], 0
    v_mov_b64 v[26:27], 0
    v_add_u32 v7, 81920, v1
    ds_write_b128 v7, v[24:27]
    ds_write_b128 v7, v[24:27] offset:768
    s_waitcnt lgkmcnt(0)
    s_add_u32 s7, s7, 0x9e3779b9
    s_mov_b64 s[40:41], s[56:57]
    s_mov_b64 s[44:45], s[58:59]
    s_mov_b64 s[48:49], s[62:63]
    s_cmp_lt_u32 s20, 2
    s_cselect_b64 s[56:57], s[56:57], s[58:59]
    s_mov_b32 s42, 524288
    s_mov_b32 s43, 0x00020000
    s_mov_b32 s46, 524288
    s_mov_b32 s47, 0x00020000
    s_mov_b32 s50, 8388608
    s_mov_b32 s51, 0x00020000
    v_lshlrev_b32 v128, 16, v16
    v_lshlrev_b32 v129, 16, v17
    v_lshlrev_b32 v18, 16, v18
    v_mul_f32 v18, 0x3fb8aa3b, v18
    v_exp_f32 v18, v18
    s_nop 0
    v_cvt_pk_bf16_f32 v18, v18, v18
    v_and_b32 v18, 0xffff0000, v18
    v_mul_f32 v126, v18, v128
    v_mul_f32 v127, v18, v129
    v_mul_f32 v126, 0x3fb8aa3b, v126
    v_mul_f32 v127, 0x3e22f983, v127
    v_mul_f32 v23, 1.0, v126
    v_mul_f32 v24, 1.0, v127
    v_exp_f32 v23, v23
    v_fract_f32 v24, v24
    v_cos_f32 v112, v24
    v_sin_f32 v113, v24
    s_nop 0
    v_mul_f32 v112, v23, v112
    v_mul_f32 v113, v23, v113
    v_mul_f32 v23, 0x41000000, v126
    v_mul_f32 v24, 0x41000000, v127
    v_exp_f32 v23, v23
    v_fract_f32 v24, v24
    v_cos_f32 v114, v24
    v_sin_f32 v115, v24
    s_nop 0
    v_mul_f32 v114, v23, v114
    v_mul_f32 v115, v23, v115
    v_mul_f32 v23, 0x41800000, v126
    v_mul_f32 v24, 0x41800000, v127
    v_exp_f32 v23, v23
    v_fract_f32 v24, v24
    v_cos_f32 v116, v24
    v_sin_f32 v117, v24
    s_nop 0
    v_mul_f32 v116, v23, v116
    v_mul_f32 v117, v23, v117
    v_mul_f32 v23, 0x43000000, v126
    v_mul_f32 v24, 0x43000000, v127
    v_exp_f32 v23, v23
    v_fract_f32 v24, v24
    v_cos_f32 v118, v24
    v_sin_f32 v119, v24
    s_nop 0
    v_mul_f32 v118, v23, v118
    v_mul_f32 v119, v23, v119
    v_mul_f32 v23, 0x44800000, v126
    v_mul_f32 v24, 0x44800000, v127
    v_exp_f32 v23, v23
    v_fract_f32 v24, v24
    v_cos_f32 v120, v24
    v_sin_f32 v121, v24
    s_nop 0
    v_mul_f32 v120, v23, v120
    v_mul_f32 v121, v23, v121
    v_mul_f32 v23, v159, v126
    v_mul_f32 v24, v159, v127
    v_exp_f32 v23, v23
    v_fract_f32 v24, v24
    v_cos_f32 v122, v24
    v_sin_f32 v123, v24
    s_nop 0
    v_mul_f32 v122, v23, v122
    v_mul_f32 v123, v23, v123
    v_mul_f32 v23, v128, v128
    v_fmac_f32 v23, v129, v129
    v_rcp_f32 v23, v23
    v_subrev_f32 v24, 1.0, v112
    v_add_f32 v23, v23, v23
    v_mul_f32 v124, v24, v128
    v_fmac_f32 v124, v113, v129
    v_mul_f32 v125, v113, v128
    v_fma_f32 v125, -v24, v129, v125
    v_mul_f32 v124, v23, v124
    v_mul_f32 v125, v23, v125
    v_mov_b64 v[80:81], 0
    v_mov_b32 v82, s7
    v_mov_b64 v[84:85], 0
    v_mov_b32 v86, s7
    v_mov_b64 v[88:89], 0
    v_mov_b32 v90, s7
    v_mov_b64 v[92:93], 0
    v_mov_b32 v94, s7
    v_mov_b64 v[96:97], 0
    v_mov_b32 v98, s7
    v_mov_b64 v[100:101], 0
    v_mov_b32 v102, s7
    v_mov_b64 v[104:105], 0
    v_mov_b32 v106, s7
    v_mov_b64 v[108:109], 0
    v_mov_b32 v110, s7
    v_and_b32 v23, 1, v0
    v_lshlrev_b32 v23, 4, v23
    v_lshlrev_b32 v21, v23, v21
    v_bfe_u32 v23, v0, 3, 1
    v_xor_b32 v23, v23, v20
    v_bfe_u32 v24, v0, 1, 2
    v_lshl_or_b32 v23, v23, 3, v24
    v_bfe_u32 v24, v0, 4, 1
    v_lshl_or_b32 v23, v24, 2, v23
    v_cmp_eq_u32 vcc, 0, v23
    s_nop 1
    v_cndmask_b32 v8, 0, v21, vcc
    v_cmp_eq_u32 vcc, 1, v23
    s_nop 1
    v_cndmask_b32 v9, 0, v21, vcc
    v_cmp_eq_u32 vcc, 2, v23
    s_nop 1
    v_cndmask_b32 v10, 0, v21, vcc
    v_cmp_eq_u32 vcc, 3, v23
    s_nop 1
    v_cndmask_b32 v11, 0, v21, vcc
    v_cmp_eq_u32 vcc, 4, v23
    s_nop 1
    v_cndmask_b32 v12, 0, v21, vcc
    v_cmp_eq_u32 vcc, 5, v23
    s_nop 1
    v_cndmask_b32 v13, 0, v21, vcc
    v_cmp_eq_u32 vcc, 6, v23
    s_nop 1
    v_cndmask_b32 v14, 0, v21, vcc
    v_cmp_eq_u32 vcc, 7, v23
    s_nop 1
    v_cndmask_b32 v15, 0, v21, vcc
    s_setprio 2
    v_mov_b32 v160, 160008
    s_mov_b32 s39, 65536
Ls_kv:
    ds_read_b32 v161, v160
    s_sub_u32 s39, s39, 1
    s_cbranch_scc1 Ls_kv_x
    s_waitcnt lgkmcnt(0)
    v_readfirstlane_b32 s33, v161
    s_cmp_ge_u32 s33, 8
    s_cbranch_scc1 Ls_kv_x
    s_sleep 4
    s_branch Ls_kv
Ls_kv_x:
    s_waitcnt lgkmcnt(0)
    v_mov_b32 v160, 160032
    s_add_u32 s35, s23, 0
    s_and_b32 s35, s35, 7
    s_lshl_b32 s35, s35, 7
    s_add_u32 m0, s55, 0
    s_add_u32 s34, s35, s25
    buffer_load_dwordx4 v148, s[16:19], s34 offen offset:0 lds
    buffer_load_dwordx4 v149, s[16:19], s34 offen offset:1024 lds
    s_add_u32 m0, s54, 0
    s_add_u32 s34, s35, s24
    buffer_load_dwordx4 v144, s[12:15], s34 offen offset:0 lds
    buffer_load_dwordx4 v145, s[12:15], s34 offen offset:1024 lds
    buffer_load_dwordx4 v146, s[12:15], s34 offen offset:2048 lds
    buffer_load_dwordx4 v147, s[12:15], s34 offen offset:3072 lds
    s_add_u32 s35, s23, 1
    s_and_b32 s35, s35, 7
    s_lshl_b32 s35, s35, 7
    s_add_u32 m0, s55, 24576
    s_add_u32 s34, s35, s25
    buffer_load_dwordx4 v148, s[16:19], s34 offen offset:0 lds
    buffer_load_dwordx4 v149, s[16:19], s34 offen offset:1024 lds
    s_add_u32 m0, s54, 24576
    s_add_u32 s34, s35, s24
    buffer_load_dwordx4 v144, s[12:15], s34 offen offset:0 lds
    buffer_load_dwordx4 v145, s[12:15], s34 offen offset:1024 lds
    buffer_load_dwordx4 v146, s[12:15], s34 offen offset:2048 lds
    buffer_load_dwordx4 v147, s[12:15], s34 offen offset:3072 lds
    s_waitcnt vmcnt(6)
    s_mov_b64 exec, 1
    ds_add_u32 v160, v167
    s_mov_b64 exec, -1
    s_mov_b32 s39, 65536
Ls_a0:
    ds_read_b32 v161, v160
    ds_read_b128 v[48:51], v136 offset:0
    ds_read_b128 v[52:55], v140 offset:0
    s_sub_u32 s39, s39, 1
    s_cbranch_scc1 Ls_a0x
    s_waitcnt lgkmcnt(0)
    v_readfirstlane_b32 s33, v161
    s_cmp_ge_u32 s33, 4
    s_cbranch_scc0 Ls_a0
Ls_a0x:
    s_waitcnt lgkmcnt(0)
    v_mfma_f32_32x32x16_bf16 v[16:31], v[48:51], v[52:55], 0
    ds_read_b128 v[56:59], v140 offset:4096
    s_add_u32 s35, s23, 2
    s_and_b32 s35, s35, 7
    s_lshl_b32 s35, s35, 7
    s_add_u32 m0, s55, 49152
    s_add_u32 s34, s35, s25
    buffer_load_dwordx4 v148, s[16:19], s34 offen offset:0 lds
    s_waitcnt lgkmcnt(0)
    v_mfma_f32_32x32x16_bf16 v[32:47], v[48:51], v[56:59], 0
    ds_read_b128 v[60:63], v137 offset:0
    ds_read_b128 v[64:67], v141 offset:0
    buffer_load_dwordx4 v149, s[16:19], s34 offen offset:1024 lds
    s_waitcnt lgkmcnt(0)
    v_mfma_f32_32x32x16_bf16 v[16:31], v[60:63], v[64:67], v[16:31]
    ds_read_b128 v[68:71], v141 offset:4096
    s_add_u32 m0, s54, 49152
    s_add_u32 s34, s35, s24
    buffer_load_dwordx4 v144, s[12:15], s34 offen offset:0 lds
    s_waitcnt lgkmcnt(0)
    v_mfma_f32_32x32x16_bf16 v[32:47], v[60:63], v[68:71], v[32:47]
    ds_read_b128 v[48:51], v138 offset:0
    ds_read_b128 v[52:55], v142 offset:0
    buffer_load_dwordx4 v145, s[12:15], s34 offen offset:1024 lds
    s_waitcnt lgkmcnt(0)
    v_mfma_f32_32x32x16_bf16 v[16:31], v[48:51], v[52:55], v[16:31]
    ds_read_b128 v[56:59], v142 offset:4096
    buffer_load_dwordx4 v146, s[12:15], s34 offen offset:2048 lds
    s_waitcnt lgkmcnt(0)
    v_mfma_f32_32x32x16_bf16 v[32:47], v[48:51], v[56:59], v[32:47]
    ds_read_b128 v[60:63], v139 offset:0
    ds_read_b128 v[64:67], v143 offset:0
    buffer_load_dwordx4 v147, s[12:15], s34 offen offset:3072 lds
    s_waitcnt lgkmcnt(0)
    v_mfma_f32_32x32x16_bf16 v[16:31], v[60:63], v[64:67], v[16:31]
    ds_read_b128 v[68:71], v143 offset:4096
    s_waitcnt lgkmcnt(0)
    v_mfma_f32_32x32x16_bf16 v[32:47], v[60:63], v[68:71], v[32:47]
    s_waitcnt vmcnt(6)
    s_mov_b64 exec, 1
    ds_add_u32 v160, v167
    s_mov_b64 exec, -1
    s_mov_b32 s39, 65536
Ls_a1:
    ds_read_b32 v161, v160
    ds_read_b128 v[48:51], v136 offset:24576
    ds_read_b128 v[52:55], v140 offset:24576
    s_sub_u32 s39, s39, 1
    s_cbranch_scc1 Ls_a1x
    s_waitcnt lgkmcnt(0)
    v_readfirstlane_b32 s33, v161
    s_cmp_ge_u32 s33, 8
    s_cbranch_scc0 Ls_a1
Ls_a1x:
    s_waitcnt lgkmcnt(0)
    v_mfma_f32_32x32x16_bf16 v[16:31], v[48:51], v[52:55], v[16:31]
    ds_read_b128 v[56:59], v140 offset:28672
    s_add_u32 s35, s23, 3
    s_and_b32 s35, s35, 7
    s_lshl_b32 s35, s35, 7
    s_add_u32 m0, s55, 0
    s_add_u32 s34, s35, s25
    buffer_load_dwordx4 v148, s[16:19], s34 offen offset:0 lds
    s_waitcnt lgkmcnt(0)
    v_mfma_f32_32x32x16_bf16 v[32:47], v[48:51], v[56:59], v[32:47]
    ds_read_b128 v[60:63], v137 offset:24576
    ds_read_b128 v[64:67], v141 offset:24576
    buffer_load_dwordx4 v149, s[16:19], s34 offen offset:1024 lds
    s_waitcnt lgkmcnt(0)
    v_mfma_f32_32x32x16_bf16 v[16:31], v[60:63], v[64:67], v[16:31]
    ds_read_b128 v[68:71], v141 offset:28672
    s_add_u32 m0, s54, 0
    s_add_u32 s34, s35, s24
    buffer_load_dwordx4 v144, s[12:15], s34 offen offset:0 lds
    s_waitcnt lgkmcnt(0)
    v_mfma_f32_32x32x16_bf16 v[32:47], v[60:63], v[68:71], v[32:47]
    ds_read_b128 v[48:51], v138 offset:24576
    ds_read_b128 v[52:55], v142 offset:24576
    buffer_load_dwordx4 v145, s[12:15], s34 offen offset:1024 lds
    s_waitcnt lgkmcnt(0)
    v_mfma_f32_32x32x16_bf16 v[16:31], v[48:51], v[52:55], v[16:31]
    ds_read_b128 v[56:59], v142 offset:28672
    buffer_load_dwordx4 v146, s[12:15], s34 offen offset:2048 lds
    s_waitcnt lgkmcnt(0)
    v_mfma_f32_32x32x16_bf16 v[32:47], v[48:51], v[56:59], v[32:47]
    ds_read_b128 v[60:63], v139 offset:24576
    ds_read_b128 v[64:67], v143 offset:24576
    buffer_load_dwordx4 v147, s[12:15], s34 offen offset:3072 lds
    s_waitcnt lgkmcnt(0)
    v_mfma_f32_32x32x16_bf16 v[16:31], v[60:63], v[64:67], v[16:31]
    ds_read_b128 v[68:71], v143 offset:28672
    s_waitcnt lgkmcnt(0)
    v_mfma_f32_32x32x16_bf16 v[32:47], v[60:63], v[68:71], v[32:47]
    s_waitcnt vmcnt(6)
    s_mov_b64 exec, 1
    ds_add_u32 v160, v167
    s_mov_b64 exec, -1
    s_mov_b32 s39, 65536
Ls_a2:
    ds_read_b32 v161, v160
    ds_read_b128 v[48:51], v136 offset:49152
    ds_read_b128 v[52:55], v140 offset:49152
    s_sub_u32 s39, s39, 1
    s_cbranch_scc1 Ls_a2x
    s_waitcnt lgkmcnt(0)
    v_readfirstlane_b32 s33, v161
    s_cmp_ge_u32 s33, 12
    s_cbranch_scc0 Ls_a2
Ls_a2x:
    s_waitcnt lgkmcnt(0)
    v_mfma_f32_32x32x16_bf16 v[16:31], v[48:51], v[52:55], v[16:31]
    ds_read_b128 v[56:59], v140 offset:53248
    s_add_u32 s35, s23, 4
    s_and_b32 s35, s35, 7
    s_lshl_b32 s35, s35, 7
    s_add_u32 m0, s55, 24576
    s_add_u32 s34, s35, s25
    buffer_load_dwordx4 v148, s[16:19], s34 offen offset:0 lds
    s_waitcnt lgkmcnt(0)
    v_mfma_f32_32x32x16_bf16 v[32:47], v[48:51], v[56:59], v[32:47]
    ds_read_b128 v[60:63], v137 offset:49152
    ds_read_b128 v[64:67], v141 offset:49152
    buffer_load_dwordx4 v149, s[16:19], s34 offen offset:1024 lds
    s_waitcnt lgkmcnt(0)
    v_mfma_f32_32x32x16_bf16 v[16:31], v[60:63], v[64:67], v[16:31]
    ds_read_b128 v[68:71], v141 offset:53248
    s_add_u32 m0, s54, 24576
    s_add_u32 s34, s35, s24
    buffer_load_dwordx4 v144, s[12:15], s34 offen offset:0 lds
    s_waitcnt lgkmcnt(0)
    v_mfma_f32_32x32x16_bf16 v[32:47], v[60:63], v[68:71], v[32:47]
    ds_read_b128 v[48:51], v138 offset:49152
    ds_read_b128 v[52:55], v142 offset:49152
    buffer_load_dwordx4 v145, s[12:15], s34 offen offset:1024 lds
    s_waitcnt lgkmcnt(0)
    v_mfma_f32_32x32x16_bf16 v[16:31], v[48:51], v[52:55], v[16:31]
    ds_read_b128 v[56:59], v142 offset:53248
    buffer_load_dwordx4 v146, s[12:15], s34 offen offset:2048 lds
    s_waitcnt lgkmcnt(0)
    v_mfma_f32_32x32x16_bf16 v[32:47], v[48:51], v[56:59], v[32:47]
    ds_read_b128 v[60:63], v139 offset:49152
    ds_read_b128 v[64:67], v143 offset:49152
    buffer_load_dwordx4 v147, s[12:15], s34 offen offset:3072 lds
    s_waitcnt lgkmcnt(0)
    v_mfma_f32_32x32x16_bf16 v[16:31], v[60:63], v[64:67], v[16:31]
    ds_read_b128 v[68:71], v143 offset:53248
    s_waitcnt lgkmcnt(0)
    v_mfma_f32_32x32x16_bf16 v[32:47], v[60:63], v[68:71], v[32:47]
    s_waitcnt vmcnt(6)
    s_mov_b64 exec, 1
    ds_add_u32 v160, v167
    s_mov_b64 exec, -1
    s_mov_b32 s39, 65536
Ls_a3:
    ds_read_b32 v161, v160
    ds_read_b128 v[48:51], v136 offset:0
    ds_read_b128 v[52:55], v140 offset:0
    s_sub_u32 s39, s39, 1
    s_cbranch_scc1 Ls_a3x
    s_waitcnt lgkmcnt(0)
    v_readfirstlane_b32 s33, v161
    s_cmp_ge_u32 s33, 16
    s_cbranch_scc0 Ls_a3
Ls_a3x:
    s_waitcnt lgkmcnt(0)
    v_mfma_f32_32x32x16_bf16 v[16:31], v[48:51], v[52:55], v[16:31]
    ds_read_b128 v[56:59], v140 offset:4096
    s_add_u32 s35, s23, 5
    s_and_b32 s35, s35, 7
    s_lshl_b32 s35, s35, 7
    s_add_u32 m0, s55, 49152
    s_add_u32 s34, s35, s25
    buffer_load_dwordx4 v148, s[16:19], s34 offen offset:0 lds
    s_waitcnt lgkmcnt(0)
    v_mfma_f32_32x32x16_bf16 v[32:47], v[48:51], v[56:59], v[32:47]
    ds_read_b128 v[60:63], v137 offset:0
    ds_read_b128 v[64:67], v141 offset:0
    buffer_load_dwordx4 v149, s[16:19], s34 offen offset:1024 lds
    s_waitcnt lgkmcnt(0)
    v_mfma_f32_32x32x16_bf16 v[16:31], v[60:63], v[64:67], v[16:31]
    ds_read_b128 v[68:71], v141 offset:4096
    s_add_u32 m0, s54, 49152
    s_add_u32 s34, s35, s24
    buffer_load_dwordx4 v144, s[12:15], s34 offen offset:0 lds
    s_waitcnt lgkmcnt(0)
    v_mfma_f32_32x32x16_bf16 v[32:47], v[60:63], v[68:71], v[32:47]
    ds_read_b128 v[48:51], v138 offset:0
    ds_read_b128 v[52:55], v142 offset:0
    buffer_load_dwordx4 v145, s[12:15], s34 offen offset:1024 lds
    s_waitcnt lgkmcnt(0)
    v_mfma_f32_32x32x16_bf16 v[16:31], v[48:51], v[52:55], v[16:31]
    ds_read_b128 v[56:59], v142 offset:4096
    buffer_load_dwordx4 v146, s[12:15], s34 offen offset:2048 lds
    s_waitcnt lgkmcnt(0)
    v_mfma_f32_32x32x16_bf16 v[32:47], v[48:51], v[56:59], v[32:47]
    ds_read_b128 v[60:63], v139 offset:0
    ds_read_b128 v[64:67], v143 offset:0
    buffer_load_dwordx4 v147, s[12:15], s34 offen offset:3072 lds
    s_waitcnt lgkmcnt(0)
    v_mfma_f32_32x32x16_bf16 v[16:31], v[60:63], v[64:67], v[16:31]
    ds_read_b128 v[68:71], v143 offset:4096
    s_waitcnt lgkmcnt(0)
    v_mfma_f32_32x32x16_bf16 v[32:47], v[60:63], v[68:71], v[32:47]
    s_waitcnt vmcnt(6)
    s_mov_b64 exec, 1
    ds_add_u32 v160, v167
    s_mov_b64 exec, -1
    s_mov_b32 s39, 65536
Ls_a4:
    ds_read_b32 v161, v160
    ds_read_b128 v[48:51], v136 offset:24576
    ds_read_b128 v[52:55], v140 offset:24576
    s_sub_u32 s39, s39, 1
    s_cbranch_scc1 Ls_a4x
    s_waitcnt lgkmcnt(0)
    v_readfirstlane_b32 s33, v161
    s_cmp_ge_u32 s33, 20
    s_cbranch_scc0 Ls_a4
Ls_a4x:
    s_waitcnt lgkmcnt(0)
    v_mfma_f32_32x32x16_bf16 v[16:31], v[48:51], v[52:55], v[16:31]
    ds_read_b128 v[56:59], v140 offset:28672
    s_add_u32 s35, s23, 6
    s_and_b32 s35, s35, 7
    s_lshl_b32 s35, s35, 7
    s_add_u32 m0, s55, 0
    s_add_u32 s34, s35, s25
    buffer_load_dwordx4 v148, s[16:19], s34 offen offset:0 lds
    s_waitcnt lgkmcnt(0)
    v_mfma_f32_32x32x16_bf16 v[32:47], v[48:51], v[56:59], v[32:47]
    ds_read_b128 v[60:63], v137 offset:24576
    ds_read_b128 v[64:67], v141 offset:24576
    buffer_load_dwordx4 v149, s[16:19], s34 offen offset:1024 lds
    s_waitcnt lgkmcnt(0)
    v_mfma_f32_32x32x16_bf16 v[16:31], v[60:63], v[64:67], v[16:31]
    ds_read_b128 v[68:71], v141 offset:28672
    s_add_u32 m0, s54, 0
    s_add_u32 s34, s35, s24
    buffer_load_dwordx4 v144, s[12:15], s34 offen offset:0 lds
    s_waitcnt lgkmcnt(0)
    v_mfma_f32_32x32x16_bf16 v[32:47], v[60:63], v[68:71], v[32:47]
    ds_read_b128 v[48:51], v138 offset:24576
    ds_read_b128 v[52:55], v142 offset:24576
    buffer_load_dwordx4 v145, s[12:15], s34 offen offset:1024 lds
    s_waitcnt lgkmcnt(0)
    v_mfma_f32_32x32x16_bf16 v[16:31], v[48:51], v[52:55], v[16:31]
    ds_read_b128 v[56:59], v142 offset:28672
    buffer_load_dwordx4 v146, s[12:15], s34 offen offset:2048 lds
    s_waitcnt lgkmcnt(0)
    v_mfma_f32_32x32x16_bf16 v[32:47], v[48:51], v[56:59], v[32:47]
    ds_read_b128 v[60:63], v139 offset:24576
    ds_read_b128 v[64:67], v143 offset:24576
    buffer_load_dwordx4 v147, s[12:15], s34 offen offset:3072 lds
    s_waitcnt lgkmcnt(0)
    v_mfma_f32_32x32x16_bf16 v[16:31], v[60:63], v[64:67], v[16:31]
    ds_read_b128 v[68:71], v143 offset:28672
    s_waitcnt lgkmcnt(0)
    v_mfma_f32_32x32x16_bf16 v[32:47], v[60:63], v[68:71], v[32:47]
    s_waitcnt vmcnt(6)
    s_mov_b64 exec, 1
    ds_add_u32 v160, v167
    s_mov_b64 exec, -1
    s_mov_b32 s39, 65536
Ls_a5:
    ds_read_b32 v161, v160
    ds_read_b128 v[48:51], v136 offset:49152
    ds_read_b128 v[52:55], v140 offset:49152
    s_sub_u32 s39, s39, 1
    s_cbranch_scc1 Ls_a5x
    s_waitcnt lgkmcnt(0)
    v_readfirstlane_b32 s33, v161
    s_cmp_ge_u32 s33, 24
    s_cbranch_scc0 Ls_a5
Ls_a5x:
    s_waitcnt lgkmcnt(0)
    v_mfma_f32_32x32x16_bf16 v[16:31], v[48:51], v[52:55], v[16:31]
    ds_read_b128 v[56:59], v140 offset:53248
    s_add_u32 s35, s23, 7
    s_and_b32 s35, s35, 7
    s_lshl_b32 s35, s35, 7
    s_add_u32 m0, s55, 24576
    s_add_u32 s34, s35, s25
    buffer_load_dwordx4 v148, s[16:19], s34 offen offset:0 lds
    s_waitcnt lgkmcnt(0)
    v_mfma_f32_32x32x16_bf16 v[32:47], v[48:51], v[56:59], v[32:47]
    ds_read_b128 v[60:63], v137 offset:49152
    ds_read_b128 v[64:67], v141 offset:49152
    buffer_load_dwordx4 v149, s[16:19], s34 offen offset:1024 lds
    s_waitcnt lgkmcnt(0)
    v_mfma_f32_32x32x16_bf16 v[16:31], v[60:63], v[64:67], v[16:31]
    ds_read_b128 v[68:71], v141 offset:53248
    s_add_u32 m0, s54, 24576
    s_add_u32 s34, s35, s24
    buffer_load_dwordx4 v144, s[12:15], s34 offen offset:0 lds
    s_waitcnt lgkmcnt(0)
    v_mfma_f32_32x32x16_bf16 v[32:47], v[60:63], v[68:71], v[32:47]
    ds_read_b128 v[48:51], v138 offset:49152
    ds_read_b128 v[52:55], v142 offset:49152
    buffer_load_dwordx4 v145, s[12:15], s34 offen offset:1024 lds
    s_waitcnt lgkmcnt(0)
    v_mfma_f32_32x32x16_bf16 v[16:31], v[48:51], v[52:55], v[16:31]
    ds_read_b128 v[56:59], v142 offset:53248
    buffer_load_dwordx4 v146, s[12:15], s34 offen offset:2048 lds
    s_waitcnt lgkmcnt(0)
    v_mfma_f32_32x32x16_bf16 v[32:47], v[48:51], v[56:59], v[32:47]
    ds_read_b128 v[60:63], v139 offset:49152
    ds_read_b128 v[64:67], v143 offset:49152
    buffer_load_dwordx4 v147, s[12:15], s34 offen offset:3072 lds
    s_waitcnt lgkmcnt(0)
    v_mfma_f32_32x32x16_bf16 v[16:31], v[60:63], v[64:67], v[16:31]
    ds_read_b128 v[68:71], v143 offset:53248
    global_load_dword v157, v157, s[56:57]
    s_waitcnt lgkmcnt(0)
    v_mfma_f32_32x32x16_bf16 v[32:47], v[60:63], v[68:71], v[32:47]
    s_waitcnt vmcnt(7)
    s_mov_b64 exec, 1
    ds_add_u32 v160, v167
    s_mov_b64 exec, -1
    s_mov_b32 s39, 65536
Ls_a6:
    ds_read_b32 v161, v160
    ds_read_b128 v[48:51], v136 offset:0
    ds_read_b128 v[52:55], v140 offset:0
    s_sub_u32 s39, s39, 1
    s_cbranch_scc1 Ls_a6x
    s_waitcnt lgkmcnt(0)
    v_readfirstlane_b32 s33, v161
    s_cmp_ge_u32 s33, 28
    s_cbranch_scc0 Ls_a6
Ls_a6x:
    s_waitcnt lgkmcnt(0)
    v_mfma_f32_32x32x16_bf16 v[16:31], v[48:51], v[52:55], v[16:31]
    ds_read_b128 v[56:59], v140 offset:4096
    global_load_dword v158, v158, s[60:61]
    s_waitcnt lgkmcnt(0)
    v_mfma_f32_32x32x16_bf16 v[32:47], v[48:51], v[56:59], v[32:47]
    ds_read_b128 v[60:63], v137 offset:0
    ds_read_b128 v[64:67], v141 offset:0
    s_waitcnt lgkmcnt(0)
    v_mfma_f32_32x32x16_bf16 v[16:31], v[60:63], v[64:67], v[16:31]
    ds_read_b128 v[68:71], v141 offset:4096
    s_waitcnt lgkmcnt(0)
    v_mfma_f32_32x32x16_bf16 v[32:47], v[60:63], v[68:71], v[32:47]
    ds_read_b128 v[48:51], v138 offset:0
    ds_read_b128 v[52:55], v142 offset:0
    s_waitcnt lgkmcnt(0)
    v_mfma_f32_32x32x16_bf16 v[16:31], v[48:51], v[52:55], v[16:31]
    ds_read_b128 v[56:59], v142 offset:4096
    s_waitcnt lgkmcnt(0)
    v_mfma_f32_32x32x16_bf16 v[32:47], v[48:51], v[56:59], v[32:47]
    ds_read_b128 v[60:63], v139 offset:0
    ds_read_b128 v[64:67], v143 offset:0
    s_waitcnt lgkmcnt(0)
    v_mfma_f32_32x32x16_bf16 v[16:31], v[60:63], v[64:67], v[16:31]
    ds_read_b128 v[68:71], v143 offset:4096
    s_waitcnt lgkmcnt(0)
    v_mfma_f32_32x32x16_bf16 v[32:47], v[60:63], v[68:71], v[32:47]
    s_waitcnt vmcnt(2)
    s_mov_b64 exec, 1
    ds_add_u32 v160, v167
    s_mov_b64 exec, -1
    s_mov_b32 s39, 65536
Ls_a7:
    ds_read_b32 v161, v160
    ds_read_b128 v[48:51], v136 offset:24576
    ds_read_b128 v[52:55], v140 offset:24576
    s_sub_u32 s39, s39, 1
    s_cbranch_scc1 Ls_a7x
    s_waitcnt lgkmcnt(0)
    v_readfirstlane_b32 s33, v161
    s_cmp_ge_u32 s33, 32
    s_cbranch_scc0 Ls_a7
Ls_a7x:
    s_waitcnt lgkmcnt(0)
    v_mfma_f32_32x32x16_bf16 v[16:31], v[48:51], v[52:55], v[16:31]
    ds_read_b128 v[56:59], v140 offset:28672
    s_waitcnt lgkmcnt(0)
    v_mfma_f32_32x32x16_bf16 v[32:47], v[48:51], v[56:59], v[32:47]
    ds_read_b128 v[60:63], v137 offset:24576
    ds_read_b128 v[64:67], v141 offset:24576
    s_waitcnt lgkmcnt(0)
    v_mfma_f32_32x32x16_bf16 v[16:31], v[60:63], v[64:67], v[16:31]
    ds_read_b128 v[68:71], v141 offset:28672
    s_waitcnt lgkmcnt(0)
    v_mfma_f32_32x32x16_bf16 v[32:47], v[60:63], v[68:71], v[32:47]
    ds_read_b128 v[48:51], v138 offset:24576
    ds_read_b128 v[52:55], v142 offset:24576
    s_waitcnt lgkmcnt(0)
    v_mfma_f32_32x32x16_bf16 v[16:31], v[48:51], v[52:55], v[16:31]
    ds_read_b128 v[56:59], v142 offset:28672
    s_waitcnt lgkmcnt(0)
    v_mfma_f32_32x32x16_bf16 v[32:47], v[48:51], v[56:59], v[32:47]
    ds_read_b128 v[60:63], v139 offset:24576
    ds_read_b128 v[64:67], v143 offset:24576
    s_waitcnt lgkmcnt(0)
    v_mfma_f32_32x32x16_bf16 v[16:31], v[60:63], v[64:67], v[16:31]
    ds_read_b128 v[68:71], v143 offset:28672
    s_waitcnt lgkmcnt(0)
    v_mfma_f32_32x32x16_bf16 v[32:47], v[60:63], v[68:71], v[32:47]
    s_lshl_b32 s34, s22, 13
    s_lshl_b32 s33, s21, 9
    s_add_u32 s34, s34, s33
    s_add_u32 s34, s34, 12582912
    v_mov_b32 v78, s7
    v_mov_b32 v79, s7
    s_nop 6
    v_pk_fma_f32 v[52:53], v[112:113], v[16:17], v[18:19] op_sel:[0,0,0] op_sel_hi:[0,1,1]
    v_pk_fma_f32 v[54:55], v[112:113], v[32:33], v[34:35] op_sel:[0,0,0] op_sel_hi:[0,1,1]
    v_pk_fma_f32 v[52:53], v[112:113], v[32:33], v[52:53] op_sel:[1,0,0] op_sel_hi:[1,1,1] neg_lo:[1,0,0] neg_hi:[1,0,0]
    v_pk_fma_f32 v[54:55], v[112:113], v[16:17], v[54:55] op_sel:[1,0,0] op_sel_hi:[1,1,1]
    v_pk_fma_f32 v[48:49], v[112:113], v[52:53], v[20:21] op_sel:[0,0,0] op_sel_hi:[0,1,1]
    v_pk_fma_f32 v[50:51], v[112:113], v[54:55], v[36:37] op_sel:[0,0,0] op_sel_hi:[0,1,1]
    v_pk_fma_f32 v[48:49], v[112:113], v[54:55], v[48:49] op_sel:[1,0,0] op_sel_hi:[1,1,1] neg_lo:[1,0,0] neg_hi:[1,0,0]
    v_pk_fma_f32 v[50:51], v[112:113], v[52:53], v[50:51] op_sel:[1,0,0] op_sel_hi:[1,1,1]
    v_pk_fma_f32 v[52:53], v[112:113], v[48:49], v[22:23] op_sel:[0,0,0] op_sel_hi:[0,1,1]
    v_pk_fma_f32 v[54:55], v[112:113], v[50:51], v[38:39] op_sel:[0,0,0] op_sel_hi:[0,1,1]
    v_pk_fma_f32 v[52:53], v[112:113], v[50:51], v[52:53] op_sel:[1,0,0] op_sel_hi:[1,1,1] neg_lo:[1,0,0] neg_hi:[1,0,0]
    v_pk_fma_f32 v[54:55], v[112:113], v[48:49], v[54:55] op_sel:[1,0,0] op_sel_hi:[1,1,1]
    v_pk_fma_f32 v[48:49], v[112:113], v[52:53], v[24:25] op_sel:[0,0,0] op_sel_hi:[0,1,1]
    v_pk_fma_f32 v[50:51], v[112:113], v[54:55], v[40:41] op_sel:[0,0,0] op_sel_hi:[0,1,1]
    v_pk_fma_f32 v[48:49], v[112:113], v[54:55], v[48:49] op_sel:[1,0,0] op_sel_hi:[1,1,1] neg_lo:[1,0,0] neg_hi:[1,0,0]
    v_pk_fma_f32 v[50:51], v[112:113], v[52:53], v[50:51] op_sel:[1,0,0] op_sel_hi:[1,1,1]
    v_pk_fma_f32 v[52:53], v[112:113], v[48:49], v[26:27] op_sel:[0,0,0] op_sel_hi:[0,1,1]
    v_pk_fma_f32 v[54:55], v[112:113], v[50:51], v[42:43] op_sel:[0,0,0] op_sel_hi:[0,1,1]
    v_pk_fma_f32 v[52:53], v[112:113], v[50:51], v[52:53] op_sel:[1,0,0] op_sel_hi:[1,1,1] neg_lo:[1,0,0] neg_hi:[1,0,0]
    v_pk_fma_f32 v[54:55], v[112:113], v[48:49], v[54:55] op_sel:[1,0,0] op_sel_hi:[1,1,1]
    v_pk_fma_f32 v[48:49], v[112:113], v[52:53], v[28:29] op_sel:[0,0,0] op_sel_hi:[0,1,1]
    v_pk_fma_f32 v[50:51], v[112:113], v[54:55], v[44:45] op_sel:[0,0,0] op_sel_hi:[0,1,1]
    v_pk_fma_f32 v[48:49], v[112:113], v[54:55], v[48:49] op_sel:[1,0,0] op_sel_hi:[1,1,1] neg_lo:[1,0,0] neg_hi:[1,0,0]
    v_pk_fma_f32 v[50:51], v[112:113], v[52:53], v[50:51] op_sel:[1,0,0] op_sel_hi:[1,1,1]
    v_pk_fma_f32 v[52:53], v[112:113], v[48:49], v[30:31] op_sel:[0,0,0] op_sel_hi:[0,1,1]
    v_pk_fma_f32 v[54:55], v[112:113], v[50:51], v[46:47] op_sel:[0,0,0] op_sel_hi:[0,1,1]
    v_pk_fma_f32 v[52:53], v[112:113], v[50:51], v[52:53] op_sel:[1,0,0] op_sel_hi:[1,1,1] neg_lo:[1,0,0] neg_hi:[1,0,0]
    v_pk_fma_f32 v[54:55], v[112:113], v[48:49], v[54:55] op_sel:[1,0,0] op_sel_hi:[1,1,1]
    v_mov_b32 v56, v52
    v_mov_b32 v57, v54
    v_mov_b32 v58, v53
    v_mov_b32 v59, v55
    v_pk_fma_f32 v[60:61], v[114:115], v[56:57], v[58:59] op_sel:[0,0,0] op_sel_hi:[0,1,1]
    v_pk_fma_f32 v[60:61], v[114:115], v[56:57], v[60:61] op_sel:[1,1,0] op_sel_hi:[1,0,1] neg_lo:[1,0,0]
    ds_write_b64 v150, v[60:61]
    s_waitcnt lgkmcnt(0)
    v_mov_b32 v160, 160000
    v_mov_b32 v161, 1
    s_mov_b64 exec, 1
    ds_add_u32 v160, v161
    s_mov_b64 exec, -1
    s_mov_b32 s39, 65536
Ls_s0:
    ds_read_b32 v161, v160
    s_sub_u32 s39, s39, 1
    s_cbranch_scc1 Ls_s0_x
    s_waitcnt lgkmcnt(0)
    v_readfirstlane_b32 s33, v161
    s_cmp_ge_u32 s33, 4
    s_cbranch_scc1 Ls_s0_x
    s_sleep 1
    s_branch Ls_s0
Ls_s0_x:
    s_waitcnt lgkmcnt(0)
    ds_read_b64 v[62:63], v151 offset:0
    ds_read_b64 v[64:65], v151 offset:256
    ds_read_b64 v[66:67], v151 offset:512
    ds_read_b64 v[68:69], v151 offset:768
    ds_read_b64 v[70:71], v151 offset:1024
    ds_read_b64 v[72:73], v151 offset:1280
    ds_read_b64 v[74:75], v151 offset:1536
    s_waitcnt lgkmcnt(0)
    v_pk_fma_f32 v[52:53], v[116:117], v[62:63], v[64:65] op_sel:[0,0,0] op_sel_hi:[0,1,1]
    v_pk_fma_f32 v[52:53], v[116:117], v[62:63], v[52:53] op_sel:[1,1,0] op_sel_hi:[1,0,1] neg_lo:[1,0,0]
    v_pk_fma_f32 v[50:51], v[116:117], v[52:53], v[66:67] op_sel:[0,0,0] op_sel_hi:[0,1,1]
    v_pk_fma_f32 v[50:51], v[116:117], v[52:53], v[50:51] op_sel:[1,1,0] op_sel_hi:[1,0,1] neg_lo:[1,0,0]
    v_pk_fma_f32 v[52:53], v[116:117], v[50:51], v[68:69] op_sel:[0,0,0] op_sel_hi:[0,1,1]
    v_pk_fma_f32 v[52:53], v[116:117], v[50:51], v[52:53] op_sel:[1,1,0] op_sel_hi:[1,0,1] neg_lo:[1,0,0]
    v_pk_fma_f32 v[50:51], v[116:117], v[52:53], v[70:71] op_sel:[0,0,0] op_sel_hi:[0,1,1]
    v_pk_fma_f32 v[50:51], v[116:117], v[52:53], v[50:51] op_sel:[1,1,0] op_sel_hi:[1,0,1] neg_lo:[1,0,0]
    v_pk_fma_f32 v[52:53], v[116:117], v[50:51], v[72:73] op_sel:[0,0,0] op_sel_hi:[0,1,1]
    v_pk_fma_f32 v[52:53], v[116:117], v[50:51], v[52:53] op_sel:[1,1,0] op_sel_hi:[1,0,1] neg_lo:[1,0,0]
    v_pk_fma_f32 v[48:49], v[116:117], v[52:53], v[74:75] op_sel:[0,0,0] op_sel_hi:[0,1,1]
    v_pk_fma_f32 v[48:49], v[116:117], v[52:53], v[48:49] op_sel:[1,1,0] op_sel_hi:[1,0,1] neg_lo:[1,0,0]
    v_pk_fma_f32 v[76:77], v[116:117], v[48:49], v[60:61] op_sel:[0,0,0] op_sel_hi:[0,1,1]
    v_pk_fma_f32 v[76:77], v[116:117], v[48:49], v[76:77] op_sel:[1,1,0] op_sel_hi:[1,0,1] neg_lo:[1,0,0]
    s_cmp_eq_u32 s20, 3
    s_cbranch_scc0 Ls_nopub
    s_mov_b32 exec_lo, 0
    buffer_store_dwordx4 v[76:79], v152, s[8:11], s34 offen sc1
    s_mov_b32 exec_lo, -1
Ls_nopub:
    s_cmp_eq_u32 s20, 0
    s_cbranch_scc0 Ls_gw
    v_lshrrev_b32 v7, 5, v0
    v_lshl_add_u32 v152, v7, 12, v152
    s_sub_u32 s34, s34, 8192
    s_mov_b32 s39, 65536
Ls_ep:
    s_cmp_ge_u32 s21, 16
    s_cselect_b32 exec_lo, -1, 0
    s_cmp_ge_u32 s21, 8
    s_cselect_b32 exec_hi, -1, 0
    buffer_load_dwordx3 v[80:82], v152, s[8:11], s34 offen offset:0 sc1
    s_cmp_ge_u32 s21, 15
    s_cselect_b32 exec_lo, -1, 0
    s_cmp_ge_u32 s21, 7
    s_cselect_b32 exec_hi, -1, 0
    buffer_load_dwordx3 v[84:86], v152, s[8:11], s34 offen offset:512 sc1
    s_cmp_ge_u32 s21, 14
    s_cselect_b32 exec_lo, -1, 0
    s_cmp_ge_u32 s21, 6
    s_cselect_b32 exec_hi, -1, 0
    buffer_load_dwordx3 v[88:90], v152, s[8:11], s34 offen offset:1024 sc1
    s_cmp_ge_u32 s21, 13
    s_cselect_b32 exec_lo, -1, 0
    s_cmp_ge_u32 s21, 5
    s_cselect_b32 exec_hi, -1, 0
    buffer_load_dwordx3 v[92:94], v152, s[8:11], s34 offen offset:1536 sc1
    s_cmp_ge_u32 s21, 12
    s_cselect_b32 exec_lo, -1, 0
    s_cmp_ge_u32 s21, 4
    s_cselect_b32 exec_hi, -1, 0
    buffer_load_dwordx3 v[96:98], v152, s[8:11], s34 offen offset:2048 sc1
    s_cmp_ge_u32 s21, 11
    s_cselect_b32 exec_lo, -1, 0
    s_cmp_ge_u32 s21, 3
    s_cselect_b32 exec_hi, -1, 0
    buffer_load_dwordx3 v[100:102], v152, s[8:11], s34 offen offset:2560 sc1
    s_cmp_ge_u32 s21, 10
    s_cselect_b32 exec_lo, -1, 0
    s_cmp_ge_u32 s21, 2
    s_cselect_b32 exec_hi, -1, 0
    buffer_load_dwordx3 v[104:106], v152, s[8:11], s34 offen offset:3072 sc1
    s_cmp_ge_u32 s21, 9
    s_cselect_b32 exec_lo, -1, 0
    s_cmp_ge_u32 s21, 1
    s_cselect_b32 exec_hi, -1, 0
    buffer_load_dwordx3 v[108:110], v152, s[8:11], s34 offen offset:3584 sc1
    s_mov_b64 exec, -1
    s_sub_u32 s39, s39, 1
    s_cbranch_scc1 Ls_ex
    s_waitcnt vmcnt(0)
    v_xor_b32 v7, v78, v82
    v_bitop3_b32 v7, v7, v86, v78 bitop3:0xf6
    v_bitop3_b32 v7, v7, v90, v78 bitop3:0xf6
    v_bitop3_b32 v7, v7, v94, v78 bitop3:0xf6
    v_bitop3_b32 v7, v7, v98, v78 bitop3:0xf6
    v_bitop3_b32 v7, v7, v102, v78 bitop3:0xf6
    v_bitop3_b32 v7, v7, v106, v78 bitop3:0xf6
    v_bitop3_b32 v7, v7, v110, v78 bitop3:0xf6
    v_cmp_ne_u32 vcc, 0, v7
    s_and_b64 vcc, exec, vcc
    s_cbranch_vccz Ls_ex
    s_sleep 3
    s_branch Ls_ep
Ls_ex:
    s_waitcnt vmcnt(0)
    v_pk_fma_f32 v[52:53], v[118:119], v[80:81], v[84:85] op_sel:[0,0,0] op_sel_hi:[0,1,1]
    v_pk_fma_f32 v[52:53], v[118:119], v[80:81], v[52:53] op_sel:[1,1,0] op_sel_hi:[1,0,1] neg_lo:[1,0,0]
    v_pk_fma_f32 v[50:51], v[118:119], v[52:53], v[88:89] op_sel:[0,0,0] op_sel_hi:[0,1,1]
    v_pk_fma_f32 v[50:51], v[118:119], v[52:53], v[50:51] op_sel:[1,1,0] op_sel_hi:[1,0,1] neg_lo:[1,0,0]
    v_pk_fma_f32 v[52:53], v[118:119], v[50:51], v[92:93] op_sel:[0,0,0] op_sel_hi:[0,1,1]
    v_pk_fma_f32 v[52:53], v[118:119], v[50:51], v[52:53] op_sel:[1,1,0] op_sel_hi:[1,0,1] neg_lo:[1,0,0]
    v_pk_fma_f32 v[50:51], v[118:119], v[52:53], v[96:97] op_sel:[0,0,0] op_sel_hi:[0,1,1]
    v_pk_fma_f32 v[50:51], v[118:119], v[52:53], v[50:51] op_sel:[1,1,0] op_sel_hi:[1,0,1] neg_lo:[1,0,0]
    v_pk_fma_f32 v[52:53], v[118:119], v[50:51], v[100:101] op_sel:[0,0,0] op_sel_hi:[0,1,1]
    v_pk_fma_f32 v[52:53], v[118:119], v[50:51], v[52:53] op_sel:[1,1,0] op_sel_hi:[1,0,1] neg_lo:[1,0,0]
    v_pk_fma_f32 v[50:51], v[118:119], v[52:53], v[104:105] op_sel:[0,0,0] op_sel_hi:[0,1,1]
    v_pk_fma_f32 v[50:51], v[118:119], v[52:53], v[50:51] op_sel:[1,1,0] op_sel_hi:[1,0,1] neg_lo:[1,0,0]
    v_pk_fma_f32 v[62:63], v[118:119], v[50:51], v[108:109] op_sel:[0,0,0] op_sel_hi:[0,1,1]
    v_pk_fma_f32 v[62:63], v[118:119], v[50:51], v[62:63] op_sel:[1,1,0] op_sel_hi:[1,0,1] neg_lo:[1,0,0]
    v_mov_b32 v64, v62
    v_mov_b32 v65, v63
    s_nop 1
    v_permlane32_swap_b32 v62, v64
    v_permlane32_swap_b32 v63, v65
    s_nop 1
    v_pk_fma_f32 v[66:67], v[120:121], v[62:63], v[64:65] op_sel:[0,0,0] op_sel_hi:[0,1,1]
    v_pk_fma_f32 v[66:67], v[120:121], v[62:63], v[66:67] op_sel:[1,1,0] op_sel_hi:[1,0,1] neg_lo:[1,0,0]
    ds_write_b64 v153, v[66:67]
    v_mov_b32 v160, 160012
    v_mov_b32 v161, 1
    s_mov_b64 exec, 1
    ds_add_u32 v160, v161
    s_mov_b64 exec, -1
Ls_gw:
    v_mov_b32 v160, 160012
    s_mov_b32 s39, 65536
Ls_g:
    ds_read_b32 v161, v160
    s_sub_u32 s39, s39, 1
    s_cbranch_scc1 Ls_g_x
    s_waitcnt lgkmcnt(0)
    v_readfirstlane_b32 s33, v161
    s_cmp_ge_u32 s33, 1
    s_cbranch_scc1 Ls_g_x
    s_sleep 6
    s_branch Ls_g
Ls_g_x:
    s_waitcnt lgkmcnt(0)
    ds_read_b64 v[66:67], v153
    s_lshl_b32 s34, s29, 4
    s_add_u32 s34, s34, s22
    s_and_b32 s35, s34, 31
    s_lshl_b32 s35, s35, 2
    s_lshr_b32 s33, s29, 1
    s_mul_i32 s33, s33, 4352
    s_add_u32 s35, s35, s33
    s_add_u32 s35, s35, 12713984
    s_lshl_b32 s34, s34, 12
    s_add_u32 s34, s34, 8388608
    s_waitcnt lgkmcnt(0)
    v_pk_fma_f32 v[50:51], v[122:123], v[66:67], v[48:49] op_sel:[0,0,0] op_sel_hi:[0,1,1]
    v_pk_fma_f32 v[50:51], v[122:123], v[66:67], v[50:51] op_sel:[1,1,0] op_sel_hi:[1,0,1] neg_lo:[1,0,0]
    v_pk_fma_f32 v[52:53], v[114:115], v[50:51], v[56:57] op_sel:[0,0,0] op_sel_hi:[0,1,1]
    v_pk_fma_f32 v[52:53], v[114:115], v[50:51], v[52:53] op_sel:[1,1,0] op_sel_hi:[1,0,1] neg_lo:[1,0,0]
    v_mov_b32 v72, v50
    v_mov_b32 v73, v52
    v_mov_b32 v74, v51
    v_mov_b32 v75, v53
    v_pk_fma_f32 v[16:17], v[112:113], v[72:73], v[16:17] op_sel:[0,0,0] op_sel_hi:[0,1,1]
    v_pk_fma_f32 v[32:33], v[112:113], v[74:75], v[32:33] op_sel:[0,0,0] op_sel_hi:[0,1,1]
    v_pk_fma_f32 v[16:17], v[112:113], v[74:75], v[16:17] op_sel:[1,0,0] op_sel_hi:[1,1,1] neg_lo:[1,0,0] neg_hi:[1,0,0]
    v_pk_fma_f32 v[32:33], v[112:113], v[72:73], v[32:33] op_sel:[1,0,0] op_sel_hi:[1,1,1]
    v_pk_mul_f32 v[64:65], v[124:125], v[16:17] op_sel:[0,0] op_sel_hi:[0,1]
    v_pk_mul_f32 v[66:67], v[124:125], v[16:17] op_sel:[1,0] op_sel_hi:[1,1] neg_lo:[1,0] neg_hi:[1,0]
    v_pk_fma_f32 v[64:65], v[124:125], v[32:33], v[64:65] op_sel:[1,0,0] op_sel_hi:[1,1,1] neg_lo:[1,0,0] neg_hi:[1,0,0]
    v_pk_fma_f32 v[66:67], v[124:125], v[32:33], v[66:67] op_sel:[0,0,0] op_sel_hi:[0,1,1] neg_lo:[1,0,0] neg_hi:[1,0,0]
    v_pk_fma_f32 v[18:19], v[112:113], v[16:17], v[18:19] op_sel:[0,0,0] op_sel_hi:[0,1,1]
    v_pk_fma_f32 v[34:35], v[112:113], v[32:33], v[34:35] op_sel:[0,0,0] op_sel_hi:[0,1,1]
    v_pk_fma_f32 v[18:19], v[112:113], v[32:33], v[18:19] op_sel:[1,0,0] op_sel_hi:[1,1,1] neg_lo:[1,0,0] neg_hi:[1,0,0]
    v_pk_fma_f32 v[34:35], v[112:113], v[16:17], v[34:35] op_sel:[1,0,0] op_sel_hi:[1,1,1]
    v_pk_mul_f32 v[68:69], v[124:125], v[18:19] op_sel:[0,0] op_sel_hi:[0,1]
    v_pk_mul_f32 v[70:71], v[124:125], v[18:19] op_sel:[1,0] op_sel_hi:[1,1] neg_lo:[1,0] neg_hi:[1,0]
    v_pk_fma_f32 v[68:69], v[124:125], v[34:35], v[68:69] op_sel:[1,0,0] op_sel_hi:[1,1,1] neg_lo:[1,0,0] neg_hi:[1,0,0]
    v_pk_fma_f32 v[70:71], v[124:125], v[34:35], v[70:71] op_sel:[0,0,0] op_sel_hi:[0,1,1] neg_lo:[1,0,0] neg_hi:[1,0,0]
    v_cvt_pk_bf16_f32 v48, v64, v68
    v_cvt_pk_bf16_f32 v56, v66, v70
    v_cvt_pk_bf16_f32 v52, v65, v69
    v_cvt_pk_bf16_f32 v60, v67, v71
    v_pk_fma_f32 v[20:21], v[112:113], v[18:19], v[20:21] op_sel:[0,0,0] op_sel_hi:[0,1,1]
    v_pk_fma_f32 v[36:37], v[112:113], v[34:35], v[36:37] op_sel:[0,0,0] op_sel_hi:[0,1,1]
    v_pk_fma_f32 v[20:21], v[112:113], v[34:35], v[20:21] op_sel:[1,0,0] op_sel_hi:[1,1,1] neg_lo:[1,0,0] neg_hi:[1,0,0]
    v_pk_fma_f32 v[36:37], v[112:113], v[18:19], v[36:37] op_sel:[1,0,0] op_sel_hi:[1,1,1]
    v_pk_mul_f32 v[64:65], v[124:125], v[20:21] op_sel:[0,0] op_sel_hi:[0,1]
    v_pk_mul_f32 v[66:67], v[124:125], v[20:21] op_sel:[1,0] op_sel_hi:[1,1] neg_lo:[1,0] neg_hi:[1,0]
    v_pk_fma_f32 v[64:65], v[124:125], v[36:37], v[64:65] op_sel:[1,0,0] op_sel_hi:[1,1,1] neg_lo:[1,0,0] neg_hi:[1,0,0]
    v_pk_fma_f32 v[66:67], v[124:125], v[36:37], v[66:67] op_sel:[0,0,0] op_sel_hi:[0,1,1] neg_lo:[1,0,0] neg_hi:[1,0,0]
    v_pk_fma_f32 v[22:23], v[112:113], v[20:21], v[22:23] op_sel:[0,0,0] op_sel_hi:[0,1,1]
    v_pk_fma_f32 v[38:39], v[112:113], v[36:37], v[38:39] op_sel:[0,0,0] op_sel_hi:[0,1,1]
    v_pk_fma_f32 v[22:23], v[112:113], v[36:37], v[22:23] op_sel:[1,0,0] op_sel_hi:[1,1,1] neg_lo:[1,0,0] neg_hi:[1,0,0]
    v_pk_fma_f32 v[38:39], v[112:113], v[20:21], v[38:39] op_sel:[1,0,0] op_sel_hi:[1,1,1]
    v_pk_mul_f32 v[68:69], v[124:125], v[22:23] op_sel:[0,0] op_sel_hi:[0,1]
    v_pk_mul_f32 v[70:71], v[124:125], v[22:23] op_sel:[1,0] op_sel_hi:[1,1] neg_lo:[1,0] neg_hi:[1,0]
    v_pk_fma_f32 v[68:69], v[124:125], v[38:39], v[68:69] op_sel:[1,0,0] op_sel_hi:[1,1,1] neg_lo:[1,0,0] neg_hi:[1,0,0]
    v_pk_fma_f32 v[70:71], v[124:125], v[38:39], v[70:71] op_sel:[0,0,0] op_sel_hi:[0,1,1] neg_lo:[1,0,0] neg_hi:[1,0,0]
    v_cvt_pk_bf16_f32 v49, v64, v68
    v_cvt_pk_bf16_f32 v57, v66, v70
    v_cvt_pk_bf16_f32 v53, v65, v69
    v_cvt_pk_bf16_f32 v61, v67, v71
    v_pk_fma_f32 v[24:25], v[112:113], v[22:23], v[24:25] op_sel:[0,0,0] op_sel_hi:[0,1,1]
    v_pk_fma_f32 v[40:41], v[112:113], v[38:39], v[40:41] op_sel:[0,0,0] op_sel_hi:[0,1,1]
    v_pk_fma_f32 v[24:25], v[112:113], v[38:39], v[24:25] op_sel:[1,0,0] op_sel_hi:[1,1,1] neg_lo:[1,0,0] neg_hi:[1,0,0]
    v_pk_fma_f32 v[40:41], v[112:113], v[22:23], v[40:41] op_sel:[1,0,0] op_sel_hi:[1,1,1]
    v_pk_mul_f32 v[64:65], v[124:125], v[24:25] op_sel:[0,0] op_sel_hi:[0,1]
    v_pk_mul_f32 v[66:67], v[124:125], v[24:25] op_sel:[1,0] op_sel_hi:[1,1] neg_lo:[1,0] neg_hi:[1,0]
    v_pk_fma_f32 v[64:65], v[124:125], v[40:41], v[64:65] op_sel:[1,0,0] op_sel_hi:[1,1,1] neg_lo:[1,0,0] neg_hi:[1,0,0]
    v_pk_fma_f32 v[66:67], v[124:125], v[40:41], v[66:67] op_sel:[0,0,0] op_sel_hi:[0,1,1] neg_lo:[1,0,0] neg_hi:[1,0,0]
    v_pk_fma_f32 v[26:27], v[112:113], v[24:25], v[26:27] op_sel:[0,0,0] op_sel_hi:[0,1,1]
    v_pk_fma_f32 v[42:43], v[112:113], v[40:41], v[42:43] op_sel:[0,0,0] op_sel_hi:[0,1,1]
    v_pk_fma_f32 v[26:27], v[112:113], v[40:41], v[26:27] op_sel:[1,0,0] op_sel_hi:[1,1,1] neg_lo:[1,0,0] neg_hi:[1,0,0]
    v_pk_fma_f32 v[42:43], v[112:113], v[24:25], v[42:43] op_sel:[1,0,0] op_sel_hi:[1,1,1]
    v_pk_mul_f32 v[68:69], v[124:125], v[26:27] op_sel:[0,0] op_sel_hi:[0,1]
    v_pk_mul_f32 v[70:71], v[124:125], v[26:27] op_sel:[1,0] op_sel_hi:[1,1] neg_lo:[1,0] neg_hi:[1,0]
    v_pk_fma_f32 v[68:69], v[124:125], v[42:43], v[68:69] op_sel:[1,0,0] op_sel_hi:[1,1,1] neg_lo:[1,0,0] neg_hi:[1,0,0]
    v_pk_fma_f32 v[70:71], v[124:125], v[42:43], v[70:71] op_sel:[0,0,0] op_sel_hi:[0,1,1] neg_lo:[1,0,0] neg_hi:[1,0,0]
    v_cvt_pk_bf16_f32 v50, v64, v68
    v_cvt_pk_bf16_f32 v58, v66, v70
    v_cvt_pk_bf16_f32 v54, v65, v69
    v_cvt_pk_bf16_f32 v62, v67, v71
    v_pk_fma_f32 v[28:29], v[112:113], v[26:27], v[28:29] op_sel:[0,0,0] op_sel_hi:[0,1,1]
    v_pk_fma_f32 v[44:45], v[112:113], v[42:43], v[44:45] op_sel:[0,0,0] op_sel_hi:[0,1,1]
    v_pk_fma_f32 v[28:29], v[112:113], v[42:43], v[28:29] op_sel:[1,0,0] op_sel_hi:[1,1,1] neg_lo:[1,0,0] neg_hi:[1,0,0]
    v_pk_fma_f32 v[44:45], v[112:113], v[26:27], v[44:45] op_sel:[1,0,0] op_sel_hi:[1,1,1]
    v_pk_mul_f32 v[64:65], v[124:125], v[28:29] op_sel:[0,0] op_sel_hi:[0,1]
    v_pk_mul_f32 v[66:67], v[124:125], v[28:29] op_sel:[1,0] op_sel_hi:[1,1] neg_lo:[1,0] neg_hi:[1,0]
    v_pk_fma_f32 v[64:65], v[124:125], v[44:45], v[64:65] op_sel:[1,0,0] op_sel_hi:[1,1,1] neg_lo:[1,0,0] neg_hi:[1,0,0]
    v_pk_fma_f32 v[66:67], v[124:125], v[44:45], v[66:67] op_sel:[0,0,0] op_sel_hi:[0,1,1] neg_lo:[1,0,0] neg_hi:[1,0,0]
    v_pk_fma_f32 v[30:31], v[112:113], v[28:29], v[30:31] op_sel:[0,0,0] op_sel_hi:[0,1,1]
    v_pk_fma_f32 v[46:47], v[112:113], v[44:45], v[46:47] op_sel:[0,0,0] op_sel_hi:[0,1,1]
    v_pk_fma_f32 v[30:31], v[112:113], v[44:45], v[30:31] op_sel:[1,0,0] op_sel_hi:[1,1,1] neg_lo:[1,0,0] neg_hi:[1,0,0]
    v_pk_fma_f32 v[46:47], v[112:113], v[28:29], v[46:47] op_sel:[1,0,0] op_sel_hi:[1,1,1]
    v_pk_mul_f32 v[68:69], v[124:125], v[30:31] op_sel:[0,0] op_sel_hi:[0,1]
    v_pk_mul_f32 v[70:71], v[124:125], v[30:31] op_sel:[1,0] op_sel_hi:[1,1] neg_lo:[1,0] neg_hi:[1,0]
    v_pk_fma_f32 v[68:69], v[124:125], v[46:47], v[68:69] op_sel:[1,0,0] op_sel_hi:[1,1,1] neg_lo:[1,0,0] neg_hi:[1,0,0]
    v_pk_fma_f32 v[70:71], v[124:125], v[46:47], v[70:71] op_sel:[0,0,0] op_sel_hi:[0,1,1] neg_lo:[1,0,0] neg_hi:[1,0,0]
    v_cvt_pk_bf16_f32 v51, v64, v68
    v_cvt_pk_bf16_f32 v59, v66, v70
    v_cvt_pk_bf16_f32 v55, v65, v69
    v_cvt_pk_bf16_f32 v63, v67, v71
    ds_write_b128 v154, v[48:51]
    ds_write_b128 v154, v[52:55] offset:16
    ds_read_b64_tr_b16 v[80:81], v155 offset:0
    ds_read_b64_tr_b16 v[82:83], v155 offset:256
    ds_read_b64_tr_b16 v[84:85], v155 offset:1024
    ds_read_b64_tr_b16 v[86:87], v155 offset:1280
    ds_write_b128 v154, v[56:59]
    ds_write_b128 v154, v[60:63] offset:16
    ds_read_b64_tr_b16 v[88:89], v155 offset:0
    ds_read_b64_tr_b16 v[90:91], v155 offset:256
    ds_read_b64_tr_b16 v[92:93], v155 offset:1024
    ds_read_b64_tr_b16 v[94:95], v155 offset:1280
    s_waitcnt lgkmcnt(4)
    buffer_store_dwordx4 v[80:83], v1, s[8:11], s34 offen offset:0 sc1
    buffer_store_dwordx4 v[84:87], v1, s[8:11], s34 offen offset:1024 sc1
    s_waitcnt lgkmcnt(0)
    buffer_store_dwordx4 v[88:91], v1, s[8:11], s34 offen offset:2048 sc1
    buffer_store_dwordx4 v[92:95], v1, s[8:11], s34 offen offset:3072 sc1
    s_lshl_b32 s24, s27, 17
    s_lshl_b32 s33, s20, 14
    s_add_u32 s24, s24, s33
    s_add_u32 s24, s24, 8388608
    s_mul_i32 s34, s27, 4352
    s_add_u32 s34, s34, 12713984
    s_waitcnt vmcnt(0)
    s_mov_b64 exec, 1
    buffer_store_dword v78, v1, s[8:11], s35 offen
    s_mov_b64 exec, -1
    s_add_u32 m0, s26, 0
    s_add_u32 s35, s36, 0
    buffer_load_dwordx4 v2, s[40:43], s35 offen offset:0 lds
    buffer_load_dwordx4 v3, s[40:43], s35 offen offset:1024 lds
    s_add_u32 m0, s26, 2048
    s_add_u32 s35, s36, 16384
    buffer_load_dwordx4 v2, s[40:43], s35 offen offset:0 lds
    buffer_load_dwordx4 v3, s[40:43], s35 offen offset:1024 lds
    s_add_u32 m0, s26, 4096
    s_add_u32 s35, s36, 32768
    buffer_load_dwordx4 v2, s[40:43], s35 offen offset:0 lds
    buffer_load_dwordx4 v3, s[40:43], s35 offen offset:1024 lds
    s_add_u32 m0, s26, 6144
    s_add_u32 s35, s36, 49152
    buffer_load_dwordx4 v2, s[40:43], s35 offen offset:0 lds
    buffer_load_dwordx4 v3, s[40:43], s35 offen offset:1024 lds
    s_add_u32 m0, s26, 8192
    s_add_u32 s35, s36, 0
    buffer_load_dwordx4 v2, s[44:47], s35 offen offset:0 lds
    buffer_load_dwordx4 v3, s[44:47], s35 offen offset:1024 lds
    s_add_u32 m0, s26, 10240
    s_add_u32 s35, s36, 16384
    buffer_load_dwordx4 v2, s[44:47], s35 offen offset:0 lds
    buffer_load_dwordx4 v3, s[44:47], s35 offen offset:1024 lds
    s_add_u32 m0, s26, 12288
    s_add_u32 s35, s36, 32768
    buffer_load_dwordx4 v2, s[44:47], s35 offen offset:0 lds
    buffer_load_dwordx4 v3, s[44:47], s35 offen offset:1024 lds
    s_add_u32 m0, s26, 14336
    s_add_u32 s35, s36, 49152
    buffer_load_dwordx4 v2, s[44:47], s35 offen offset:0 lds
    buffer_load_dwordx4 v3, s[44:47], s35 offen offset:1024 lds
    s_cmp_eq_u32 s20, 0
    s_cbranch_scc0 Ls_hw
    s_mov_b32 s39, 65536
Ls_hp:
    buffer_load_dword v7, v4, s[8:11], s34 offen sc1
    s_sub_u32 s39, s39, 1
    s_cbranch_scc1 Ls_hp_x
    s_waitcnt vmcnt(0)
    v_cmp_ne_u32 vcc, s7, v7
    s_and_b64 vcc, exec, vcc
    s_cbranch_vccz Ls_hp_x
    s_sleep 2
    s_branch Ls_hp
Ls_hp_x:
    v_mov_b32 v160, 160016
    v_mov_b32 v161, 1
    s_mov_b64 exec, 1
    ds_add_u32 v160, v161
    s_mov_b64 exec, -1
Ls_hw:
    v_mov_b32 v160, 160016
    s_mov_b32 s39, 65536
Ls_h:
    ds_read_b32 v161, v160
    s_sub_u32 s39, s39, 1
    s_cbranch_scc1 Ls_h_x
    s_waitcnt lgkmcnt(0)
    v_readfirstlane_b32 s33, v161
    s_cmp_ge_u32 s33, 1
    s_cbranch_scc1 Ls_h_x
    s_sleep 6
    s_branch Ls_h
Ls_h_x:
    s_waitcnt lgkmcnt(0)
    s_sub_u32 s33, s26, s54
    v_add_u32 v152, s33, v136
    v_add_u32 v153, s33, v137
    v_add_u32 v154, s33, v138
    v_add_u32 v155, s33, v139
    s_add_u32 s33, s24, 0
    buffer_load_dwordx4 v[80:83], v1, s[8:11], s33 offen offset:0 sc1
    s_add_u32 s33, s24, 65536
    buffer_load_dwordx4 v[84:87], v1, s[8:11], s33 offen offset:0 sc1
    s_add_u32 s33, s24, 0
    buffer_load_dwordx4 v[88:91], v1, s[8:11], s33 offen offset:1024 sc1
    s_add_u32 s33, s24, 65536
    buffer_load_dwordx4 v[92:95], v1, s[8:11], s33 offen offset:1024 sc1
    s_add_u32 s33, s24, 4096
    buffer_load_dwordx4 v[96:99], v1, s[8:11], s33 offen offset:0 sc1
    s_add_u32 s33, s24, 69632
    buffer_load_dwordx4 v[100:103], v1, s[8:11], s33 offen offset:0 sc1
    s_add_u32 s33, s24, 4096
    buffer_load_dwordx4 v[104:107], v1, s[8:11], s33 offen offset:1024 sc1
    s_add_u32 s33, s24, 69632
    buffer_load_dwordx4 v[108:111], v1, s[8:11], s33 offen offset:1024 sc1
    buffer_load_dwordx4 v[156:159], v6, s[12:15], s38 offen offset:0
    buffer_load_dwordx4 v[164:167], v6, s[12:15], s38 offen offset:32
    s_waitcnt vmcnt(22)
    ds_read_b128 v[144:147], v152 offset:0
    s_add_u32 s33, s24, 0
    buffer_load_dwordx4 v[112:115], v1, s[8:11], s33 offen offset:2048 sc1
    s_waitcnt vmcnt(9)
    s_waitcnt lgkmcnt(0)
    v_mfma_f32_32x32x16_bf16 v[16:31], v[144:147], v[80:83], 0
    ds_read_b128 v[148:151], v152 offset:0
    s_add_u32 s33, s24, 65536
    buffer_load_dwordx4 v[116:119], v1, s[8:11], s33 offen offset:2048 sc1
    s_waitcnt lgkmcnt(0)
    v_mfma_f32_32x32x16_bf16 v[48:63], v[148:151], v[84:87], 0
    ds_read_b128 v[144:147], v153 offset:0
    s_add_u32 s33, s24, 0
    buffer_load_dwordx4 v[120:123], v1, s[8:11], s33 offen offset:3072 sc1
    s_waitcnt vmcnt(9)
    s_waitcnt lgkmcnt(0)
    v_mfma_f32_32x32x16_bf16 v[16:31], v[144:147], v[88:91], v[16:31]
    ds_read_b128 v[148:151], v153 offset:0
    s_add_u32 s33, s24, 65536
    buffer_load_dwordx4 v[124:127], v1, s[8:11], s33 offen offset:3072 sc1
    s_waitcnt lgkmcnt(0)
    v_mfma_f32_32x32x16_bf16 v[48:63], v[148:151], v[92:95], v[48:63]
    ds_read_b128 v[144:147], v154 offset:0
    s_add_u32 s33, s24, 4096
    buffer_load_dwordx4 v[128:131], v1, s[8:11], s33 offen offset:2048 sc1
    s_waitcnt vmcnt(9)
    s_waitcnt lgkmcnt(0)
    v_mfma_f32_32x32x16_bf16 v[16:31], v[144:147], v[96:99], v[16:31]
    ds_read_b128 v[148:151], v154 offset:0
    s_add_u32 s33, s24, 69632
    buffer_load_dwordx4 v[132:135], v1, s[8:11], s33 offen offset:2048 sc1
    s_waitcnt lgkmcnt(0)
    v_mfma_f32_32x32x16_bf16 v[48:63], v[148:151], v[100:103], v[48:63]
    ds_read_b128 v[144:147], v155 offset:0
    s_add_u32 s33, s24, 4096
    buffer_load_dwordx4 v[136:139], v1, s[8:11], s33 offen offset:3072 sc1
    s_waitcnt vmcnt(9)
    s_waitcnt lgkmcnt(0)
    v_mfma_f32_32x32x16_bf16 v[16:31], v[144:147], v[104:107], v[16:31]
    ds_read_b128 v[148:151], v155 offset:0
    s_add_u32 s33, s24, 69632
    buffer_load_dwordx4 v[140:143], v1, s[8:11], s33 offen offset:3072 sc1
    s_waitcnt lgkmcnt(0)
    v_mfma_f32_32x32x16_bf16 v[48:63], v[148:151], v[108:111], v[48:63]
    ds_read_b128 v[144:147], v152 offset:4096
    s_add_u32 m0, s26, 0
    s_add_u32 s35, s36, 128
    buffer_load_dwordx4 v2, s[40:43], s35 offen offset:0 lds
    s_waitcnt lgkmcnt(0)
    v_mfma_f32_32x32x16_bf16 v[32:47], v[144:147], v[80:83], 0
    ds_read_b128 v[148:151], v152 offset:4096
    buffer_load_dwordx4 v3, s[40:43], s35 offen offset:1024 lds
    s_waitcnt lgkmcnt(0)
    v_mfma_f32_32x32x16_bf16 v[64:79], v[148:151], v[84:87], 0
    ds_read_b128 v[144:147], v153 offset:4096
    s_add_u32 m0, s26, 2048
    s_add_u32 s35, s36, 16512
    buffer_load_dwordx4 v2, s[40:43], s35 offen offset:0 lds
    s_waitcnt lgkmcnt(0)
    v_mfma_f32_32x32x16_bf16 v[32:47], v[144:147], v[88:91], v[32:47]
    ds_read_b128 v[148:151], v153 offset:4096
    buffer_load_dwordx4 v3, s[40:43], s35 offen offset:1024 lds
    s_waitcnt lgkmcnt(0)
    v_mfma_f32_32x32x16_bf16 v[64:79], v[148:151], v[92:95], v[64:79]
    ds_read_b128 v[144:147], v154 offset:4096
    s_waitcnt lgkmcnt(0)
    v_mfma_f32_32x32x16_bf16 v[32:47], v[144:147], v[96:99], v[32:47]
    ds_read_b128 v[148:151], v154 offset:4096
    s_waitcnt lgkmcnt(0)
    v_mfma_f32_32x32x16_bf16 v[64:79], v[148:151], v[100:103], v[64:79]
    ds_read_b128 v[144:147], v155 offset:4096
    s_waitcnt lgkmcnt(0)
    v_mfma_f32_32x32x16_bf16 v[32:47], v[144:147], v[104:107], v[32:47]
    ds_read_b128 v[148:151], v155 offset:4096
    s_waitcnt lgkmcnt(0)
    v_mfma_f32_32x32x16_bf16 v[64:79], v[148:151], v[108:111], v[64:79]
    s_waitcnt vmcnt(12)
    s_cmp_eq_u32 s20, 0
    s_cbranch_scc0 Ls_k0
    v_mfma_f32_32x32x16_bf16 v[16:31], v[8:11], v[156:159], v[16:31]
    v_mfma_f32_32x32x16_bf16 v[16:31], v[12:15], v[164:167], v[16:31]
    s_branch Ls_k3x
Ls_k0:
    s_cmp_eq_u32 s20, 1
    s_cbranch_scc0 Ls_k1
    v_mfma_f32_32x32x16_bf16 v[32:47], v[8:11], v[156:159], v[32:47]
    v_mfma_f32_32x32x16_bf16 v[32:47], v[12:15], v[164:167], v[32:47]
    s_branch Ls_k3x
Ls_k1:
    s_cmp_eq_u32 s20, 2
    s_cbranch_scc0 Ls_k2
    v_mfma_f32_32x32x16_bf16 v[48:63], v[8:11], v[156:159], v[48:63]
    v_mfma_f32_32x32x16_bf16 v[48:63], v[12:15], v[164:167], v[48:63]
    s_branch Ls_k3x
Ls_k2:
    v_mfma_f32_32x32x16_bf16 v[64:79], v[8:11], v[156:159], v[64:79]
    v_mfma_f32_32x32x16_bf16 v[64:79], v[12:15], v[164:167], v[64:79]
Ls_k3x:
    s_lshl_b32 s33, s20, 12
    s_add_u32 s33, s33, 86016
    v_lshrrev_b32 v7, 3, v0
    v_and_b32 v5, 7, v0
    v_xor_b32 v166, v7, v5
    v_lshlrev_b32 v166, 4, v166
    v_lshl_add_u32 v166, v7, 7, v166
    v_add_u32 v166, s33, v166
    v_lshlrev_b32 v5, 4, v5
    v_lshl_add_u32 v5, v7, 12, v5
    v_lshrrev_b32 v7, 5, v0
    v_and_b32 v4, 7, v0
    v_xor_b32 v7, v7, v4
    v_lshlrev_b32 v7, 4, v7
    v_and_b32 v4, 31, v0
    v_lshl_add_u32 v7, v4, 7, v7
    v_xor_b32 v4, 0, v7
    v_add_u32 v162, s26, v4
    v_xor_b32 v4, 32, v7
    v_add_u32 v163, s26, v4
    v_xor_b32 v4, 64, v7
    v_add_u32 v164, s26, v4
    v_xor_b32 v4, 96, v7
    v_add_u32 v165, s26, v4
    ds_read_b128 v[144:147], v152 offset:8192
    s_add_u32 m0, s26, 4096
    s_add_u32 s35, s36, 32896
    buffer_load_dwordx4 v2, s[40:43], s35 offen offset:0 lds
    buffer_load_dwordx4 v3, s[40:43], s35 offen offset:1024 lds
    s_waitcnt vmcnt(12)
    s_waitcnt lgkmcnt(0)
    v_mfma_f32_32x32x16_bf16 v[16:31], v[144:147], v[112:115], v[16:31]
    ds_read_b128 v[148:151], v152 offset:8192
    s_add_u32 m0, s26, 6144
    s_add_u32 s35, s36, 49280
    buffer_load_dwordx4 v2, s[40:43], s35 offen offset:0 lds
    buffer_load_dwordx4 v3, s[40:43], s35 offen offset:1024 lds
    s_waitcnt lgkmcnt(0)
    v_mfma_f32_32x32x16_bf16 v[48:63], v[148:151], v[116:119], v[48:63]
    ds_read_b128 v[144:147], v153 offset:8192
    s_add_u32 s33, s24, 8192
    buffer_load_dwordx4 v[80:83], v1, s[8:11], s33 offen offset:0 sc1
    s_add_u32 s33, s24, 73728
    buffer_load_dwordx4 v[84:87], v1, s[8:11], s33 offen offset:0 sc1
    s_waitcnt vmcnt(14)
    s_waitcnt lgkmcnt(0)
    v_mfma_f32_32x32x16_bf16 v[16:31], v[144:147], v[120:123], v[16:31]
    ds_read_b128 v[148:151], v153 offset:8192
    s_add_u32 s33, s24, 8192
    buffer_load_dwordx4 v[88:91], v1, s[8:11], s33 offen offset:1024 sc1
    s_add_u32 s33, s24, 73728
    buffer_load_dwordx4 v[92:95], v1, s[8:11], s33 offen offset:1024 sc1
    s_waitcnt lgkmcnt(0)
    v_mfma_f32_32x32x16_bf16 v[48:63], v[148:151], v[124:127], v[48:63]
    ds_read_b128 v[144:147], v154 offset:8192
    s_add_u32 s33, s24, 12288
    buffer_load_dwordx4 v[96:99], v1, s[8:11], s33 offen offset:0 sc1
    s_waitcnt vmcnt(15)
    s_waitcnt lgkmcnt(0)
    v_mfma_f32_32x32x16_bf16 v[16:31], v[144:147], v[128:131], v[16:31]
    ds_read_b128 v[148:151], v154 offset:8192
    s_add_u32 s33, s24, 77824
    buffer_load_dwordx4 v[100:103], v1, s[8:11], s33 offen offset:0 sc1
    s_waitcnt lgkmcnt(0)
    v_mfma_f32_32x32x16_bf16 v[48:63], v[148:151], v[132:135], v[48:63]
    ds_read_b128 v[144:147], v155 offset:8192
    s_add_u32 s33, s24, 12288
    buffer_load_dwordx4 v[104:107], v1, s[8:11], s33 offen offset:1024 sc1
    s_waitcnt vmcnt(15)
    s_waitcnt lgkmcnt(0)
    v_mfma_f32_32x32x16_bf16 v[16:31], v[144:147], v[136:139], v[16:31]
    ds_read_b128 v[148:151], v155 offset:8192
    s_add_u32 s33, s24, 77824
    buffer_load_dwordx4 v[108:111], v1, s[8:11], s33 offen offset:1024 sc1
    s_waitcnt lgkmcnt(0)
    v_mfma_f32_32x32x16_bf16 v[48:63], v[148:151], v[140:143], v[48:63]
    ds_read_b128 v[144:147], v152 offset:12288
    s_add_u32 m0, s26, 8192
    s_add_u32 s35, s36, 128
    buffer_load_dwordx4 v2, s[44:47], s35 offen offset:0 lds
    s_waitcnt lgkmcnt(0)
    v_mfma_f32_32x32x16_bf16 v[32:47], v[144:147], v[112:115], v[32:47]
    ds_read_b128 v[148:151], v152 offset:12288
    buffer_load_dwordx4 v3, s[44:47], s35 offen offset:1024 lds
    s_waitcnt lgkmcnt(0)
    v_mfma_f32_32x32x16_bf16 v[64:79], v[148:151], v[116:119], v[64:79]
    ds_read_b128 v[144:147], v153 offset:12288
    s_add_u32 m0, s26, 10240
    s_add_u32 s35, s36, 16512
    buffer_load_dwordx4 v2, s[44:47], s35 offen offset:0 lds
    s_waitcnt lgkmcnt(0)
    v_mfma_f32_32x32x16_bf16 v[32:47], v[144:147], v[120:123], v[32:47]
    ds_read_b128 v[148:151], v153 offset:12288
    buffer_load_dwordx4 v3, s[44:47], s35 offen offset:1024 lds
    s_waitcnt lgkmcnt(0)
    v_mfma_f32_32x32x16_bf16 v[64:79], v[148:151], v[124:127], v[64:79]
    ds_read_b128 v[144:147], v154 offset:12288
    s_waitcnt lgkmcnt(0)
    v_mfma_f32_32x32x16_bf16 v[32:47], v[144:147], v[128:131], v[32:47]
    ds_read_b128 v[148:151], v154 offset:12288
    s_waitcnt lgkmcnt(0)
    v_mfma_f32_32x32x16_bf16 v[64:79], v[148:151], v[132:135], v[64:79]
    ds_read_b128 v[144:147], v155 offset:12288
    s_waitcnt lgkmcnt(0)
    v_mfma_f32_32x32x16_bf16 v[32:47], v[144:147], v[136:139], v[32:47]
    ds_read_b128 v[148:151], v155 offset:12288
    s_waitcnt lgkmcnt(0)
    v_mfma_f32_32x32x16_bf16 v[64:79], v[148:151], v[140:143], v[64:79]
    s_add_u32 m0, s26, 12288
    s_add_u32 s35, s36, 32896
    buffer_load_dwordx4 v2, s[44:47], s35 offen offset:0 lds
    buffer_load_dwordx4 v3, s[44:47], s35 offen offset:1024 lds
    s_add_u32 m0, s26, 14336
    s_add_u32 s35, s36, 49280
    buffer_load_dwordx4 v2, s[44:47], s35 offen offset:0 lds
    buffer_load_dwordx4 v3, s[44:47], s35 offen offset:1024 lds
    s_add_u32 s33, s24, 8192
    buffer_load_dwordx4 v[112:115], v1, s[8:11], s33 offen offset:2048 sc1
    s_add_u32 s33, s24, 73728
    buffer_load_dwordx4 v[116:119], v1, s[8:11], s33 offen offset:2048 sc1
    s_add_u32 s33, s24, 8192
    buffer_load_dwordx4 v[120:123], v1, s[8:11], s33 offen offset:3072 sc1
    s_add_u32 s33, s24, 73728
    buffer_load_dwordx4 v[124:127], v1, s[8:11], s33 offen offset:3072 sc1
    s_add_u32 s33, s24, 12288
    buffer_load_dwordx4 v[128:131], v1, s[8:11], s33 offen offset:2048 sc1
    s_add_u32 s33, s24, 77824
    buffer_load_dwordx4 v[132:135], v1, s[8:11], s33 offen offset:2048 sc1
    s_add_u32 s33, s24, 12288
    buffer_load_dwordx4 v[136:139], v1, s[8:11], s33 offen offset:3072 sc1
    s_add_u32 s33, s24, 77824
    buffer_load_dwordx4 v[140:143], v1, s[8:11], s33 offen offset:3072 sc1
    v_mov_b32 v160, 160024
    s_mov_b32 s39, 65536
Ls_df:
    ds_read_b32 v161, v160
    s_sub_u32 s39, s39, 1
    s_cbranch_scc1 Ls_df_x
    s_waitcnt lgkmcnt(0)
    v_readfirstlane_b32 s33, v161
    s_cmp_ge_u32 s33, 8
    s_cbranch_scc1 Ls_df_x
    s_sleep 4
    s_branch Ls_df
Ls_df_x:
    s_waitcnt lgkmcnt(0)
    s_waitcnt vmcnt(28)
    ds_read_b128 v[144:147], v152 offset:0
    ds_read_b128 v[148:151], v153 offset:0
    ds_read_b128 v[156:159], v154 offset:0
    s_waitcnt vmcnt(22)
    s_waitcnt lgkmcnt(2)
    v_mfma_f32_32x32x16_bf16 v[16:31], v[144:147], v[80:83], v[16:31]
    s_waitcnt lgkmcnt(2)
    v_mfma_f32_32x32x16_bf16 v[48:63], v[144:147], v[84:87], v[48:63]
    ds_read_b128 v[144:147], v155 offset:0
    s_waitcnt vmcnt(20)
    s_waitcnt lgkmcnt(2)
    v_mfma_f32_32x32x16_bf16 v[16:31], v[148:151], v[88:91], v[16:31]
    s_waitcnt lgkmcnt(2)
    v_mfma_f32_32x32x16_bf16 v[48:63], v[148:151], v[92:95], v[48:63]
    s_waitcnt vmcnt(18)
    s_waitcnt lgkmcnt(1)
    v_mfma_f32_32x32x16_bf16 v[16:31], v[156:159], v[96:99], v[16:31]
    s_waitcnt lgkmcnt(1)
    v_mfma_f32_32x32x16_bf16 v[48:63], v[156:159], v[100:103], v[48:63]
    s_waitcnt vmcnt(16)
    s_waitcnt lgkmcnt(0)
    v_mfma_f32_32x32x16_bf16 v[16:31], v[144:147], v[104:107], v[16:31]
    s_waitcnt lgkmcnt(0)
    v_mfma_f32_32x32x16_bf16 v[48:63], v[144:147], v[108:111], v[48:63]
    ds_read_b128 v[144:147], v152 offset:4096
    ds_read_b128 v[148:151], v153 offset:4096
    ds_read_b128 v[156:159], v154 offset:4096
    s_waitcnt lgkmcnt(2)
    v_mfma_f32_32x32x16_bf16 v[32:47], v[144:147], v[80:83], v[32:47]
    s_waitcnt lgkmcnt(2)
    v_mfma_f32_32x32x16_bf16 v[64:79], v[144:147], v[84:87], v[64:79]
    ds_read_b128 v[144:147], v155 offset:4096
    s_waitcnt lgkmcnt(2)
    v_mfma_f32_32x32x16_bf16 v[32:47], v[148:151], v[88:91], v[32:47]
    s_waitcnt lgkmcnt(2)
    v_mfma_f32_32x32x16_bf16 v[64:79], v[148:151], v[92:95], v[64:79]
    s_waitcnt lgkmcnt(1)
    v_mfma_f32_32x32x16_bf16 v[32:47], v[156:159], v[96:99], v[32:47]
    s_waitcnt lgkmcnt(1)
    v_mfma_f32_32x32x16_bf16 v[64:79], v[156:159], v[100:103], v[64:79]
    s_waitcnt lgkmcnt(0)
    v_mfma_f32_32x32x16_bf16 v[32:47], v[144:147], v[104:107], v[32:47]
    s_waitcnt lgkmcnt(0)
    v_mfma_f32_32x32x16_bf16 v[64:79], v[144:147], v[108:111], v[64:79]
    s_waitcnt vmcnt(12)
    ds_read_b128 v[144:147], v152 offset:8192
    ds_read_b128 v[148:151], v153 offset:8192
    ds_read_b128 v[156:159], v154 offset:8192
    s_waitcnt vmcnt(6)
    s_waitcnt lgkmcnt(2)
    v_mfma_f32_32x32x16_bf16 v[16:31], v[144:147], v[112:115], v[16:31]
    s_waitcnt lgkmcnt(2)
    v_mfma_f32_32x32x16_bf16 v[48:63], v[144:147], v[116:119], v[48:63]
    ds_read_b128 v[144:147], v155 offset:8192
    s_waitcnt vmcnt(4)
    s_waitcnt lgkmcnt(2)
    v_mfma_f32_32x32x16_bf16 v[16:31], v[148:151], v[120:123], v[16:31]
    s_waitcnt lgkmcnt(2)
    v_mfma_f32_32x32x16_bf16 v[48:63], v[148:151], v[124:127], v[48:63]
    s_waitcnt vmcnt(2)
    s_waitcnt lgkmcnt(1)
    v_mfma_f32_32x32x16_bf16 v[16:31], v[156:159], v[128:131], v[16:31]
    s_waitcnt lgkmcnt(1)
    v_mfma_f32_32x32x16_bf16 v[48:63], v[156:159], v[132:135], v[48:63]
    s_waitcnt vmcnt(0)
    s_waitcnt lgkmcnt(0)
    v_mfma_f32_32x32x16_bf16 v[16:31], v[144:147], v[136:139], v[16:31]
    s_waitcnt lgkmcnt(0)
    v_mfma_f32_32x32x16_bf16 v[48:63], v[144:147], v[140:143], v[48:63]
    ds_read_b128 v[144:147], v152 offset:12288
    ds_read_b128 v[148:151], v153 offset:12288
    ds_read_b128 v[156:159], v154 offset:12288
    s_waitcnt lgkmcnt(2)
    v_mfma_f32_32x32x16_bf16 v[32:47], v[144:147], v[112:115], v[32:47]
    s_waitcnt lgkmcnt(2)
    v_mfma_f32_32x32x16_bf16 v[64:79], v[144:147], v[116:119], v[64:79]
    ds_read_b128 v[144:147], v155 offset:12288
    s_waitcnt lgkmcnt(2)
    v_mfma_f32_32x32x16_bf16 v[32:47], v[148:151], v[120:123], v[32:47]
    s_waitcnt lgkmcnt(2)
    v_mfma_f32_32x32x16_bf16 v[64:79], v[148:151], v[124:127], v[64:79]
    s_waitcnt lgkmcnt(1)
    v_mfma_f32_32x32x16_bf16 v[32:47], v[156:159], v[128:131], v[32:47]
    s_waitcnt lgkmcnt(1)
    v_mfma_f32_32x32x16_bf16 v[64:79], v[156:159], v[132:135], v[64:79]
    s_waitcnt lgkmcnt(0)
    v_mfma_f32_32x32x16_bf16 v[32:47], v[144:147], v[136:139], v[32:47]
    s_waitcnt lgkmcnt(0)
    v_mfma_f32_32x32x16_bf16 v[64:79], v[144:147], v[140:143], v[64:79]
    s_nop 11
    ds_write_b128 v162, v[16:19] offset:0
    ds_write_b128 v163, v[20:23] offset:0
    ds_write_b128 v164, v[24:27] offset:0
    ds_write_b128 v165, v[28:31] offset:0
    ds_write_b128 v162, v[32:35] offset:4096
    ds_write_b128 v163, v[36:39] offset:4096
    ds_write_b128 v164, v[40:43] offset:4096
    ds_write_b128 v165, v[44:47] offset:4096
    ds_write_b128 v162, v[48:51] offset:8192
    ds_write_b128 v163, v[52:55] offset:8192
    ds_write_b128 v164, v[56:59] offset:8192
    ds_write_b128 v165, v[60:63] offset:8192
    ds_write_b128 v162, v[64:67] offset:12288
    ds_write_b128 v163, v[68:71] offset:12288
    ds_write_b128 v164, v[72:75] offset:12288
    ds_write_b128 v165, v[76:79] offset:12288
    s_waitcnt lgkmcnt(0)
    v_mov_b32 v160, 160004
    v_mov_b32 v161, 1
    s_mov_b64 exec, 1
    ds_add_u32 v160, v161
    s_mov_b64 exec, -1
    s_mov_b32 s39, 65536
Ls_s1:
    ds_read_b32 v161, v160
    s_sub_u32 s39, s39, 1
    s_cbranch_scc1 Ls_s1_x
    s_waitcnt lgkmcnt(0)
    v_readfirstlane_b32 s33, v161
    s_cmp_ge_u32 s33, 4
    s_cbranch_scc1 Ls_s1_x
    s_sleep 1
    s_branch Ls_s1
Ls_s1_x:
    s_waitcnt lgkmcnt(0)
    ds_read_b128 v[16:19], v166 offset:0
    ds_read_b128 v[20:23], v166 offset:1024
    ds_read_b128 v[24:27], v166 offset:2048
    ds_read_b128 v[28:31], v166 offset:3072
    ds_read_b128 v[32:35], v166 offset:18432
    ds_read_b128 v[36:39], v166 offset:19456
    ds_read_b128 v[40:43], v166 offset:20480
    ds_read_b128 v[44:47], v166 offset:21504
    ds_read_b128 v[48:51], v166 offset:36864
    ds_read_b128 v[52:55], v166 offset:37888
    ds_read_b128 v[56:59], v166 offset:38912
    ds_read_b128 v[60:63], v166 offset:39936
    ds_read_b128 v[64:67], v166 offset:55296
    ds_read_b128 v[68:71], v166 offset:56320
    ds_read_b128 v[72:75], v166 offset:57344
    ds_read_b128 v[76:79], v166 offset:58368
    s_waitcnt lgkmcnt(8)
    v_pk_add_f32 v[16:17], v[16:17], v[32:33] op_sel:[0,0] op_sel_hi:[1,1]
    v_pk_add_f32 v[18:19], v[18:19], v[34:35] op_sel:[0,0] op_sel_hi:[1,1]
    v_pk_add_f32 v[20:21], v[20:21], v[36:37] op_sel:[0,0] op_sel_hi:[1,1]
    v_pk_add_f32 v[22:23], v[22:23], v[38:39] op_sel:[0,0] op_sel_hi:[1,1]
    v_pk_add_f32 v[24:25], v[24:25], v[40:41] op_sel:[0,0] op_sel_hi:[1,1]
    v_pk_add_f32 v[26:27], v[26:27], v[42:43] op_sel:[0,0] op_sel_hi:[1,1]
    v_pk_add_f32 v[28:29], v[28:29], v[44:45] op_sel:[0,0] op_sel_hi:[1,1]
    v_pk_add_f32 v[30:31], v[30:31], v[46:47] op_sel:[0,0] op_sel_hi:[1,1]
    s_waitcnt lgkmcnt(0)
    v_pk_add_f32 v[48:49], v[48:49], v[64:65] op_sel:[0,0] op_sel_hi:[1,1]
    v_pk_add_f32 v[50:51], v[50:51], v[66:67] op_sel:[0,0] op_sel_hi:[1,1]
    v_pk_add_f32 v[52:53], v[52:53], v[68:69] op_sel:[0,0] op_sel_hi:[1,1]
    v_pk_add_f32 v[54:55], v[54:55], v[70:71] op_sel:[0,0] op_sel_hi:[1,1]
    v_pk_add_f32 v[56:57], v[56:57], v[72:73] op_sel:[0,0] op_sel_hi:[1,1]
    v_pk_add_f32 v[58:59], v[58:59], v[74:75] op_sel:[0,0] op_sel_hi:[1,1]
    v_pk_add_f32 v[60:61], v[60:61], v[76:77] op_sel:[0,0] op_sel_hi:[1,1]
    v_pk_add_f32 v[62:63], v[62:63], v[78:79] op_sel:[0,0] op_sel_hi:[1,1]
    v_pk_add_f32 v[16:17], v[16:17], v[48:49] op_sel:[0,0] op_sel_hi:[1,1]
    v_pk_add_f32 v[18:19], v[18:19], v[50:51] op_sel:[0,0] op_sel_hi:[1,1]
    s_add_u32 s33, s37, 0
    buffer_store_dwordx4 v[16:19], v5, s[48:51], s33 offen sc1
    v_pk_add_f32 v[20:21], v[20:21], v[52:53] op_sel:[0,0] op_sel_hi:[1,1]
    v_pk_add_f32 v[22:23], v[22:23], v[54:55] op_sel:[0,0] op_sel_hi:[1,1]
    s_add_u32 s33, s37, 32768
    buffer_store_dwordx4 v[20:23], v5, s[48:51], s33 offen sc1
    v_pk_add_f32 v[24:25], v[24:25], v[56:57] op_sel:[0,0] op_sel_hi:[1,1]
    v_pk_add_f32 v[26:27], v[26:27], v[58:59] op_sel:[0,0] op_sel_hi:[1,1]
    s_add_u32 s33, s37, 65536
    buffer_store_dwordx4 v[24:27], v5, s[48:51], s33 offen sc1
    v_pk_add_f32 v[28:29], v[28:29], v[60:61] op_sel:[0,0] op_sel_hi:[1,1]
    v_pk_add_f32 v[30:31], v[30:31], v[62:63] op_sel:[0,0] op_sel_hi:[1,1]
    s_add_u32 s33, s37, 98304
    buffer_store_dwordx4 v[28:31], v5, s[48:51], s33 offen sc1
Ls_e:
    s_endpgm
L_end:
    s_endpgm
L_a:
    s_load_dwordx4 s[44:47], s[0:1], 88
    s_waitcnt lgkmcnt(0)
    s_mov_b32 s8, s4
    s_mov_b32 s9, s5
    s_mov_b32 s10, 0x1000000
    s_mov_b32 s11, 0x00020000
    s_mov_b32 s3, 13119488
    s_load_dword s7, s[4:5], s3
    s_mov_b32 s12, s44
    s_mov_b32 s13, s45
    s_mov_b32 s14, 0x80000
    s_mov_b32 s15, 0x00020000
    s_mov_b32 s16, s46
    s_mov_b32 s17, s47
    s_mov_b32 s18, 0x800000
    s_mov_b32 s19, 0x00020000
    s_cmp_ge_u32 s20, 4
    s_cbranch_scc1 L_idle
L_c0:
    v_and_b32 v14, 31, v0
    v_bfe_u32 v15, v0, 1, 3
    v_lshrrev_b32 v16, 5, v0
    v_xor_b32 v15, v15, v16
    v_lshlrev_b32 v15, 4, v15
    s_lshl_b32 s33, s20, 12
    v_lshl_add_u32 v14, v14, 7, s33
    v_xor_b32 v17, 0, v15
    v_add_u32 v8, v14, v17
    v_xor_b32 v17, 32, v15
    v_add_u32 v9, v14, v17
    v_xor_b32 v17, 64, v15
    v_add_u32 v10, v14, v17
    v_xor_b32 v17, 96, v15
    v_add_u32 v11, v14, v17
    v_lshlrev_b32 v14, 3, v16
    v_bfe_u32 v15, v0, 2, 2
    v_add_lshl_u32 v14, v14, v15, 6
    v_bfe_u32 v15, v0, 4, 1
    v_lshl_add_u32 v14, v15, 5, v14
    v_and_b32 v15, 3, v0
    v_lshl_add_u32 v14, v15, 3, v14
    v_add_u32 v12, 16384, v14
    v_bfe_u32 v3, v0, 4, 1
    v_lshlrev_b32 v3, 16, v3
    v_lshl_add_u32 v3, v16, 8, v3
    v_and_b32 v4, 15, v0
    v_lshl_add_u32 v3, v4, 4, v3
    v_mov_b32 v4, 0x3eb8aa3b
    v_and_b32 v2, 0x33, v0
    v_bfe_u32 v5, v0, 2, 1
    v_lshl_or_b32 v2, v5, 3, v2
    v_bfe_u32 v5, v0, 3, 1
    v_lshl_or_b32 v2, v5, 2, v2
    v_lshlrev_b32 v2, 4, v2
    v_mov_b64 v[32:33], 0
    v_mov_b64 v[34:35], 0
    v_mov_b64 v[36:37], 0
    v_mov_b64 v[38:39], 0
    v_mov_b64 v[40:41], 0
    v_mov_b64 v[42:43], 0
    v_mov_b64 v[44:45], 0
    v_mov_b64 v[46:47], 0
    v_mov_b64 v[48:49], 0
    v_mov_b64 v[50:51], 0
    v_mov_b64 v[52:53], 0
    v_mov_b64 v[54:55], 0
    v_mov_b64 v[56:57], 0
    v_mov_b64 v[58:59], 0
    v_mov_b64 v[60:61], 0
    v_mov_b64 v[62:63], 0
    v_mov_b64 v[64:65], 0
    v_mov_b64 v[66:67], 0
    v_mov_b64 v[68:69], 0
    v_mov_b64 v[70:71], 0
    v_mov_b64 v[72:73], 0
    v_mov_b64 v[74:75], 0
    v_mov_b64 v[76:77], 0
    v_mov_b64 v[78:79], 0
    s_and_b32 s35, s31, 15
    s_lshl_b32 s35, s35, 2
    s_add_u32 s35, s35, s20
    s_and_b32 s21, s31, 15
    s_lshr_b32 s33, s31, 4
    s_lshl_b32 s22, s33, 3
    s_add_u32 s22, s22, s30
    s_lshl_b32 s33, s33, 2
    s_add_u32 s23, s21, s33
    s_add_u32 s23, s21, s30
    s_lshl_b32 s33, s22, 17
    s_lshl_b32 s34, s35, 10
    s_add_u32 s36, s33, s34
    s_add_u32 s37, s36, 65536
    s_add_u32 s38, s36, 2097152
    s_add_u32 s40, s36, 2162688
    s_add_u32 s41, s36, 4194304
    s_lshl_b32 s33, s22, 8
    s_lshl_b32 s34, s35, 2
    s_add_u32 s42, s33, s34
    s_add_u32 s42, s42, 12853248
    s_mov_b32 s28, 8
    s_mov_b32 s43, 28672
    s_mov_b32 s29, 0
    s_barrier
    ds_read_b128 v[80:83], v8
    ds_read_b64_tr_b16 v[88:89], v12 offset:0
    ds_read_b64_tr_b16 v[90:91], v12 offset:256
    ds_read_b64_tr_b16 v[92:93], v12 offset:1024
    ds_read_b64_tr_b16 v[94:95], v12 offset:1280
    ds_read_b64_tr_b16 v[96:97], v12 offset:2048
    ds_read_b64_tr_b16 v[98:99], v12 offset:2304
Lqc:
    s_waitcnt lgkmcnt(4)
    v_mfma_f32_32x32x16_bf16 v[32:47], v[88:91], v[80:83], v[32:47]
    ds_read_b128 v[84:87], v9
    ds_read_b64_tr_b16 v[100:101], v12 offset:3072
    ds_read_b64_tr_b16 v[102:103], v12 offset:3328
    s_waitcnt lgkmcnt(5)
    v_mfma_f32_32x32x16_bf16 v[48:63], v[92:95], v[80:83], v[48:63]
    ds_read_b64_tr_b16 v[104:105], v12 offset:4096
    ds_read_b64_tr_b16 v[106:107], v12 offset:4352
    s_waitcnt lgkmcnt(5)
    v_mfma_f32_32x32x16_bf16 v[64:79], v[80:83], v[96:99], v[64:79]
    ds_read_b64_tr_b16 v[108:109], v12 offset:5120
    ds_read_b64_tr_b16 v[110:111], v12 offset:5376
    s_waitcnt lgkmcnt(4)
    v_mfma_f32_32x32x16_bf16 v[32:47], v[100:103], v[84:87], v[32:47]
    ds_read_b128 v[80:83], v10
    ds_read_b64_tr_b16 v[88:89], v12 offset:6144
    ds_read_b64_tr_b16 v[90:91], v12 offset:6400
    s_waitcnt lgkmcnt(5)
    v_mfma_f32_32x32x16_bf16 v[48:63], v[104:107], v[84:87], v[48:63]
    ds_read_b64_tr_b16 v[92:93], v12 offset:7168
    ds_read_b64_tr_b16 v[94:95], v12 offset:7424
    s_waitcnt lgkmcnt(5)
    v_mfma_f32_32x32x16_bf16 v[64:79], v[84:87], v[108:111], v[64:79]
    ds_read_b64_tr_b16 v[96:97], v12 offset:8192
    ds_read_b64_tr_b16 v[98:99], v12 offset:8448
    s_add_u32 s29, s29, 28672
    s_cmp_eq_u32 s29, 143360
    s_cselect_b32 s33, 0xfffe4000, s43
    s_cselect_b32 s29, 0, s29
    s_waitcnt lgkmcnt(4)
    v_mfma_f32_32x32x16_bf16 v[32:47], v[88:91], v[80:83], v[32:47]
    ds_read_b128 v[84:87], v11
    ds_read_b64_tr_b16 v[100:101], v12 offset:9216
    ds_read_b64_tr_b16 v[102:103], v12 offset:9472
    s_waitcnt lgkmcnt(5)
    v_mfma_f32_32x32x16_bf16 v[48:63], v[92:95], v[80:83], v[48:63]
    ds_read_b64_tr_b16 v[104:105], v12 offset:10240
    ds_read_b64_tr_b16 v[106:107], v12 offset:10496
    ds_read_b64_tr_b16 v[108:109], v12 offset:11264
    ds_read_b64_tr_b16 v[110:111], v12 offset:11520
    s_waitcnt lgkmcnt(7)
    v_mfma_f32_32x32x16_bf16 v[64:79], v[80:83], v[96:99], v[64:79]
    v_add_u32 v8, s33, v8
    v_add_u32 v9, s33, v9
    v_add_u32 v10, s33, v10
    v_add_u32 v11, s33, v11
    v_add_u32 v12, s33, v12
    s_waitcnt lgkmcnt(0)
    v_mfma_f32_32x32x16_bf16 v[32:47], v[100:103], v[84:87], v[32:47]
    s_barrier
    ds_read_b128 v[80:83], v8
    ds_read_b64_tr_b16 v[88:89], v12 offset:0
    ds_read_b64_tr_b16 v[90:91], v12 offset:256
    v_mfma_f32_32x32x16_bf16 v[48:63], v[104:107], v[84:87], v[48:63]
    ds_read_b64_tr_b16 v[92:93], v12 offset:1024
    ds_read_b64_tr_b16 v[94:95], v12 offset:1280
    v_mfma_f32_32x32x16_bf16 v[64:79], v[84:87], v[108:111], v[64:79]
    ds_read_b64_tr_b16 v[96:97], v12 offset:2048
    ds_read_b64_tr_b16 v[98:99], v12 offset:2304
    s_sub_u32 s28, s28, 1
    s_cmp_lg_u32 s28, 0
    s_cbranch_scc1 Lqc
    v_mov_b32 v14, 160048
    ds_read_b32 v15, v14
    s_nop 0
    v_pk_mul_f32 v[32:33], v[4:5], v[32:33] op_sel:[0,0] op_sel_hi:[0,1]
    v_pk_mul_f32 v[34:35], v[4:5], v[34:35] op_sel:[0,0] op_sel_hi:[0,1]
    v_pk_mul_f32 v[36:37], v[4:5], v[36:37] op_sel:[0,0] op_sel_hi:[0,1]
    v_pk_mul_f32 v[38:39], v[4:5], v[38:39] op_sel:[0,0] op_sel_hi:[0,1]
    v_pk_mul_f32 v[40:41], v[4:5], v[40:41] op_sel:[0,0] op_sel_hi:[0,1]
    v_pk_mul_f32 v[42:43], v[4:5], v[42:43] op_sel:[0,0] op_sel_hi:[0,1]
    v_pk_mul_f32 v[44:45], v[4:5], v[44:45] op_sel:[0,0] op_sel_hi:[0,1]
    v_pk_mul_f32 v[46:47], v[4:5], v[46:47] op_sel:[0,0] op_sel_hi:[0,1]
    v_cvt_pk_bf16_f32 v112, v32, v33
    v_cvt_pk_bf16_f32 v113, v34, v35
    v_cvt_pk_bf16_f32 v114, v36, v37
    v_cvt_pk_bf16_f32 v115, v38, v39
    v_cvt_pk_bf16_f32 v116, v40, v41
    v_cvt_pk_bf16_f32 v117, v42, v43
    v_cvt_pk_bf16_f32 v118, v44, v45
    v_cvt_pk_bf16_f32 v119, v46, v47
    s_waitcnt lgkmcnt(0)
    v_readfirstlane_b32 s33, v15
    s_cmp_eq_u32 s33, s31
    s_cbranch_scc1 L_c1
    s_mov_b32 s31, s33
    s_waitcnt vmcnt(0) lgkmcnt(0)
    s_barrier
    s_branch L_c0
L_c1:
    buffer_store_dwordx4 v[112:115], v1, s[8:11], s36 offen
    buffer_store_dwordx4 v[116:119], v1, s[8:11], s37 offen
    v_cvt_pk_bf16_f32 v120, v48, v49
    v_cvt_pk_bf16_f32 v121, v50, v51
    v_cvt_pk_bf16_f32 v122, v52, v53
    v_cvt_pk_bf16_f32 v123, v54, v55
    v_cvt_pk_bf16_f32 v124, v56, v57
    v_cvt_pk_bf16_f32 v125, v58, v59
    v_cvt_pk_bf16_f32 v126, v60, v61
    v_cvt_pk_bf16_f32 v127, v62, v63
    buffer_store_dwordx4 v[120:123], v2, s[8:11], s38 offen
    buffer_store_dwordx4 v[124:127], v2, s[8:11], s40 offen
    v_cvt_pk_bf16_f32 v128, v64, v65
    v_cvt_pk_bf16_f32 v129, v66, v67
    v_cvt_pk_bf16_f32 v130, v68, v69
    v_cvt_pk_bf16_f32 v131, v70, v71
    v_cvt_pk_bf16_f32 v132, v72, v73
    v_cvt_pk_bf16_f32 v133, v74, v75
    v_cvt_pk_bf16_f32 v134, v76, v77
    v_cvt_pk_bf16_f32 v135, v78, v79
    buffer_store_dwordx4 v[128:131], v3, s[8:11], s41 offen
    buffer_store_dwordx4 v[132:135], v3, s[8:11], s41 offen offset:512
    s_waitcnt lgkmcnt(0)
    s_add_u32 s7, s7, 0x9e3779b9
    s_lshl_b32 s21, s30, 1
    s_bfe_u32 s33, s31, 0x10003
    s_add_u32 s21, s21, s33
    s_and_b32 s33, s31, 16
    s_add_u32 s21, s21, s33
    s_and_b32 s22, s31, 7
    s_lshl_b32 s33, s21, 16
    s_lshl_b32 s34, s20, 13
    s_add_u32 s34, s34, s33
    s_add_u32 s24, s34, 2097152
    s_add_u32 s25, s34, 2101248
    s_add_u32 s26, s34, 4194304
    s_add_u32 s27, s34, 4198400
    s_lshl_b32 s34, s22, 13
    s_add_u32 s28, s34, s33
    v_lshrrev_b32 v2, 5, v0
    v_lshlrev_b32 v2, 8, v2
    v_and_b32 v7, 15, v0
    v_lshl_add_u32 v2, v7, 4, v2
    s_mul_i32 s33, s20, 1152
    v_add_u32 v3, s33, v1
    v_and_b32 v7, 31, v0
    v_lshl_add_u32 v5, v7, 2, s33
    s_lshl_b32 s33, s20, 10
    s_add_u32 s29, s28, s33
    s_add_u32 s33, s33, 73728
    v_add_u32 v6, s33, v1
    s_mov_b32 s36, 0xffff
    s_mov_b32 s37, 0xffff
    s_mov_b32 s47, 0x07060302
    v_and_b32 v7, 27, v0
    v_cmp_eq_u32 vcc, 16, v7
    v_mov_b32 v40, 0x3f803f80
    s_nop 0
    v_cndmask_b32 v40, 0, v40, vcc
    v_mov_b32 v143, 0xdddddddd
    v_mov_b64 v[144:145], 0
    v_mov_b64 v[146:147], 0
    v_mov_b64 v[148:149], 0
    v_mov_b64 v[150:151], 0
    v_mov_b64 v[152:153], 0
    v_mov_b32 v41, v40
    v_mov_b64 v[42:43], v[40:41]
    v_mov_b64 v[44:45], v[40:41]
    v_mov_b64 v[46:47], v[40:41]
    v_mov_b64 v[48:49], v[40:41]
    v_mov_b64 v[50:51], v[40:41]
    v_mov_b64 v[52:53], v[40:41]
    v_mov_b64 v[54:55], v[40:41]
    v_mov_b64 v[56:57], v[40:41]
    v_mov_b64 v[58:59], v[40:41]
    v_mov_b64 v[60:61], v[40:41]
    v_mov_b64 v[62:63], v[40:41]
    v_mov_b64 v[64:65], v[40:41]
    v_mov_b64 v[66:67], v[40:41]
    v_mov_b64 v[68:69], v[40:41]
    v_mov_b64 v[70:71], v[40:41]
    v_mov_b64 v[72:73], v[40:41]
    v_mov_b64 v[74:75], v[40:41]
    v_mov_b64 v[76:77], v[40:41]
    v_mov_b64 v[78:79], v[40:41]
    v_mov_b64 v[80:81], v[40:41]
    v_mov_b64 v[82:83], v[40:41]
    v_mov_b64 v[84:85], v[40:41]
    v_mov_b64 v[86:87], v[40:41]
    v_mov_b64 v[88:89], v[40:41]
    v_mov_b64 v[90:91], v[40:41]
    v_mov_b64 v[92:93], v[40:41]
    v_mov_b64 v[94:95], v[40:41]
    v_mov_b64 v[96:97], v[40:41]
    v_mov_b64 v[98:99], v[40:41]
    v_mov_b64 v[100:101], v[40:41]
    v_mov_b64 v[102:103], v[40:41]
    v_mov_b32 v4, s7
    s_waitcnt vmcnt(0)
    s_mov_b64 exec, 1
    buffer_store_dword v4, v1, s[8:11], s42 offen
    s_mov_b64 exec, -1
    s_branch L_att
L_idle:
    v_mov_b64 v[4:5], 0
    v_mov_b64 v[6:7], 0
    v_mov_b32 v2, 160000
    ds_write_b128 v2, v[4:7]
    ds_write_b128 v2, v[4:7] offset:16
    ds_write_b128 v2, v[4:7] offset:32
    s_waitcnt lgkmcnt(0)
    s_add_u32 s7, s7, 0x9e3779b9
    s_cmp_eq_u32 s20, 4
    s_cbranch_scc0 L_cl_0
    s_lshl_b32 s40, s30, 12
    s_add_u32 s40, s40, 13119744
    s_mov_b32 s38, s31
    s_lshl_b32 s33, s38, 7
    v_mov_b32 v8, s33
    v_mov_b32 v9, s7
    s_mov_b64 exec, 1
    buffer_atomic_swap v9, v8, s[8:11], s40 offen sc0
    s_mov_b64 exec, -1
L_cl_0:
    s_mov_b32 s41, 7
L_ib0:
    s_barrier
    s_sub_u32 s41, s41, 1
    s_cmp_lg_u32 s41, 0
    s_cbranch_scc1 L_ib0
    s_cmp_eq_u32 s20, 4
    s_cbranch_scc0 L_cl_x
    s_mov_b32 s41, 32
    s_mov_b64 exec, 1
L_cl:
    s_waitcnt vmcnt(0)
    v_readfirstlane_b32 s34, v9
    s_cmp_eq_u32 s34, s7
    s_cbranch_scc0 L_cl_ok
    s_sub_u32 s41, s41, 1
    s_cbranch_scc1 L_cl_ok
    s_add_u32 s38, s38, 1
    s_and_b32 s38, s38, 31
    s_lshl_b32 s33, s38, 7
    v_mov_b32 v8, s33
    v_mov_b32 v9, s7
    buffer_atomic_swap v9, v8, s[8:11], s40 offen sc0
    s_branch L_cl
L_cl_ok:
    v_mov_b32 v8, 160048
    v_mov_b32 v9, s38
    ds_write_b32 v8, v9
    s_mov_b64 exec, -1
    s_waitcnt lgkmcnt(0)
L_cl_x:
    s_barrier
    s_barrier
    v_mov_b32 v4, 160048
    ds_read_b32 v5, v4
    s_waitcnt lgkmcnt(0)
    v_readfirstlane_b32 s33, v5
    s_cmp_eq_u32 s33, s31
    s_cbranch_scc1 L_i1
    s_mov_b32 s31, s33
    s_waitcnt vmcnt(0) lgkmcnt(0)
    s_barrier
    s_branch L_i0
L_i1:
    s_lshl_b32 s21, s30, 1
    s_bfe_u32 s33, s31, 0x10003
    s_add_u32 s21, s21, s33
    s_and_b32 s33, s31, 16
    s_add_u32 s21, s21, s33
    s_and_b32 s22, s31, 7
    s_lshl_b32 s33, s21, 16
    s_lshl_b32 s34, s20, 13
    s_add_u32 s34, s34, s33
    s_add_u32 s24, s34, 2097152
    s_add_u32 s25, s34, 2101248
    s_add_u32 s26, s34, 4194304
    s_add_u32 s27, s34, 4198400
    s_lshl_b32 s34, s22, 13
    s_add_u32 s28, s34, s33
    v_lshrrev_b32 v2, 5, v0
    v_lshlrev_b32 v2, 8, v2
    v_and_b32 v7, 15, v0
    v_lshl_add_u32 v2, v7, 4, v2
    s_mul_i32 s33, s20, 1152
    v_add_u32 v3, s33, v1
    v_and_b32 v7, 31, v0
    v_lshl_add_u32 v5, v7, 2, s33
    s_lshl_b32 s33, s20, 10
    s_add_u32 s29, s28, s33
    s_add_u32 s33, s33, 73728
    v_add_u32 v6, s33, v1
    s_mov_b32 s36, 0xffff
    s_mov_b32 s37, 0xffff
    s_mov_b32 s47, 0x07060302
    v_and_b32 v7, 27, v0
    v_cmp_eq_u32 vcc, 16, v7
    v_mov_b32 v40, 0x3f803f80
    s_nop 0
    v_cndmask_b32 v40, 0, v40, vcc
    v_mov_b32 v143, 0xdddddddd
    v_mov_b64 v[144:145], 0
    v_mov_b64 v[146:147], 0
    v_mov_b64 v[148:149], 0
    v_mov_b64 v[150:151], 0
    v_mov_b64 v[152:153], 0
    v_mov_b32 v41, v40
    v_mov_b64 v[42:43], v[40:41]
    v_mov_b64 v[44:45], v[40:41]
    v_mov_b64 v[46:47], v[40:41]
    v_mov_b64 v[48:49], v[40:41]
    v_mov_b64 v[50:51], v[40:41]
    v_mov_b64 v[52:53], v[40:41]
    v_mov_b64 v[54:55], v[40:41]
    v_mov_b64 v[56:57], v[40:41]
    v_mov_b64 v[58:59], v[40:41]
    v_mov_b64 v[60:61], v[40:41]
    v_mov_b64 v[62:63], v[40:41]
    v_mov_b64 v[64:65], v[40:41]
    v_mov_b64 v[66:67], v[40:41]
    v_mov_b64 v[68:69], v[40:41]
    v_mov_b64 v[70:71], v[40:41]
    v_mov_b64 v[72:73], v[40:41]
    v_mov_b64 v[74:75], v[40:41]
    v_mov_b64 v[76:77], v[40:41]
    v_mov_b64 v[78:79], v[40:41]
    v_mov_b64 v[80:81], v[40:41]
    v_mov_b64 v[82:83], v[40:41]
    v_mov_b64 v[84:85], v[40:41]
    v_mov_b64 v[86:87], v[40:41]
    v_mov_b64 v[88:89], v[40:41]
    v_mov_b64 v[90:91], v[40:41]
    v_mov_b64 v[92:93], v[40:41]
    v_mov_b64 v[94:95], v[40:41]
    v_mov_b64 v[96:97], v[40:41]
    v_mov_b64 v[98:99], v[40:41]
    v_mov_b64 v[100:101], v[40:41]
    v_mov_b64 v[102:103], v[40:41]
L_att:
    s_lshl_b32 s33, s20, 3
    v_add_u32 v4, s33, v0
    s_lshl_b32 s34, s22, 3
    v_mov_b32 v7, s34
    v_cmp_eq_u32 vcc, 8, v0
    s_add_u32 s34, s34, s20
    s_lshr_b32 s33, s21, 1
    v_cndmask_b32 v4, v4, v7, vcc
    v_mov_b32 v7, s34
    v_cmp_lt_u32 vcc, 8, v0
    s_lshl_b32 s33, s33, 8
    s_add_u32 s45, s33, 12853248
    v_cndmask_b32 v4, v4, v7, vcc
    v_lshlrev_b32 v4, 2, v4
    s_mov_b32 s39, 65536
L_qp:
    buffer_load_dword v7, v4, s[8:11], s45 offen sc1
    s_sub_u32 s39, s39, 1
    s_cbranch_scc1 L_qp_x
    s_waitcnt vmcnt(0)
    v_cmp_ne_u32 vcc, s7, v7
    s_and_b64 vcc, exec, vcc
    s_cbranch_vccz L_qp_x
    s_sleep 1
    s_branch L_qp
L_qp_x:
    buffer_load_dwordx4 v[160:163], v1, s[8:11], s28 offen sc1
    buffer_load_dwordx4 v[8:11], v1, s[8:11], s24 offen offset:0 sc1
    buffer_load_dwordx4 v[12:15], v1, s[8:11], s24 offen offset:1024 sc1
    s_mov_b64 exec, s[36:37]
    buffer_load_dwordx4 v[40:43], v2, s[8:11], s26 offen offset:0 sc1
    buffer_load_dwordx4 v[44:47], v2, s[8:11], s26 offen offset:512 sc1
    s_mov_b64 exec, -1
    buffer_load_dwordx4 v[164:167], v1, s[8:11], s29 offen sc1
    buffer_load_dwordx4 v[16:19], v1, s[8:11], s24 offen offset:2048 sc1
    s_mov_b64 exec, s[36:37]
    buffer_load_dwordx4 v[48:51], v2, s[8:11], s26 offen offset:1024 sc1
    buffer_load_dwordx4 v[52:55], v2, s[8:11], s26 offen offset:1536 sc1
    s_mov_b64 exec, -1
    s_setprio 3
    s_waitcnt vmcnt(7)
    v_mfma_f32_32x32x16_bf16 v[104:119], v[8:11], v[160:163], 0
    s_nop 11
    buffer_load_dwordx4 v[20:23], v1, s[8:11], s24 offen offset:3072 sc1
    s_mov_b64 exec, s[36:37]
    buffer_load_dwordx4 v[56:59], v2, s[8:11], s26 offen offset:2048 sc1
    buffer_load_dwordx4 v[60:63], v2, s[8:11], s26 offen offset:2560 sc1
    s_mov_b64 exec, -1
    v_exp_f32 v104, v104
    v_exp_f32 v105, v105
    v_exp_f32 v106, v106
    v_exp_f32 v107, v107
    v_exp_f32 v108, v108
    s_waitcnt vmcnt(9)
    v_mfma_f32_32x32x16_bf16 v[120:135], v[12:15], v[160:163], 0
    v_exp_f32 v109, v109
    v_exp_f32 v110, v110
    v_exp_f32 v111, v111
    v_exp_f32 v112, v112
    v_exp_f32 v113, v113
    s_waitcnt vmcnt(8)
    v_smfmac_f32_32x32x32_bf16 v[144:159], v[40:43], v[104:111], v143
    v_exp_f32 v114, v114
    v_exp_f32 v115, v115
    v_exp_f32 v116, v116
    v_exp_f32 v117, v117
    v_exp_f32 v118, v118
    v_exp_f32 v119, v119
    buffer_load_dwordx4 v[24:27], v1, s[8:11], s25 offen offset:0 sc1
    s_mov_b64 exec, s[36:37]
    buffer_load_dwordx4 v[64:67], v2, s[8:11], s26 offen offset:3072 sc1
    buffer_load_dwordx4 v[68:71], v2, s[8:11], s26 offen offset:3584 sc1
    s_mov_b64 exec, -1
    s_waitcnt vmcnt(9)
    ds_write_b128 v6, v[164:167]
    v_add_u32 v6, 73728, v1
    v_exp_f32 v120, v120
    v_exp_f32 v121, v121
    v_smfmac_f32_32x32x32_bf16 v[144:159], v[44:47], v[112:119], v143
    v_exp_f32 v122, v122
    v_exp_f32 v123, v123
    v_exp_f32 v124, v124
    s_waitcnt vmcnt(8)
    v_mfma_f32_32x32x16_bf16 v[104:119], v[16:19], v[160:163], 0
    v_exp_f32 v125, v125
    v_exp_f32 v126, v126
    v_exp_f32 v127, v127
    v_exp_f32 v128, v128
    v_exp_f32 v129, v129
    s_waitcnt vmcnt(7)
    v_smfmac_f32_32x32x32_bf16 v[144:159], v[48:51], v[120:127], v143
    v_exp_f32 v130, v130
    v_exp_f32 v131, v131
    v_exp_f32 v132, v132
    v_exp_f32 v133, v133
    v_exp_f32 v134, v134
    v_exp_f32 v135, v135
    buffer_load_dwordx4 v[28:31], v1, s[8:11], s25 offen offset:1024 sc1
    s_mov_b64 exec, s[36:37]
    buffer_load_dwordx4 v[72:75], v2, s[8:11], s27 offen offset:0 sc1
    buffer_load_dwordx4 v[76:79], v2, s[8:11], s27 offen offset:512 sc1
    s_mov_b64 exec, -1
    v_exp_f32 v104, v104
    v_exp_f32 v105, v105
    s_waitcnt vmcnt(9)
    v_smfmac_f32_32x32x32_bf16 v[144:159], v[52:55], v[128:135], v143
    v_exp_f32 v106, v106
    v_exp_f32 v107, v107
    v_exp_f32 v108, v108
    s_waitcnt vmcnt(8)
    v_mfma_f32_32x32x16_bf16 v[120:135], v[20:23], v[160:163], 0
    v_exp_f32 v109, v109
    v_exp_f32 v110, v110
    v_exp_f32 v111, v111
    v_exp_f32 v112, v112
    v_exp_f32 v113, v113
    s_waitcnt vmcnt(7)
    v_smfmac_f32_32x32x32_bf16 v[144:159], v[56:59], v[104:111], v143
    v_exp_f32 v114, v114
    v_exp_f32 v115, v115
    v_exp_f32 v116, v116
    v_exp_f32 v117, v117
    v_exp_f32 v118, v118
    v_exp_f32 v119, v119
    buffer_load_dwordx4 v[32:35], v1, s[8:11], s25 offen offset:2048 sc1
    s_mov_b64 exec, s[36:37]
    buffer_load_dwordx4 v[80:83], v2, s[8:11], s27 offen offset:1024 sc1
    buffer_load_dwordx4 v[84:87], v2, s[8:11], s27 offen offset:1536 sc1
    s_mov_b64 exec, -1
    s_setprio 2
    v_exp_f32 v120, v120
    v_exp_f32 v121, v121
    s_waitcnt vmcnt(9)
    v_smfmac_f32_32x32x32_bf16 v[144:159], v[60:63], v[112:119], v143
    v_exp_f32 v122, v122
    v_exp_f32 v123, v123
    v_exp_f32 v124, v124
    s_waitcnt vmcnt(8)
    v_mfma_f32_32x32x16_bf16 v[104:119], v[24:27], v[160:163], 0
    v_exp_f32 v125, v125
    v_exp_f32 v126, v126
    v_exp_f32 v127, v127
    v_exp_f32 v128, v128
    v_exp_f32 v129, v129
    s_waitcnt vmcnt(7)
    v_smfmac_f32_32x32x32_bf16 v[144:159], v[64:67], v[120:127], v143
    v_exp_f32 v130, v130
    v_exp_f32 v131, v131
    v_exp_f32 v132, v132
    v_exp_f32 v133, v133
    v_exp_f32 v134, v134
    v_exp_f32 v135, v135
    buffer_load_dwordx4 v[36:39], v1, s[8:11], s25 offen offset:3072 sc1
    s_mov_b64 exec, s[36:37]
    buffer_load_dwordx4 v[88:91], v2, s[8:11], s27 offen offset:2048 sc1
    buffer_load_dwordx4 v[92:95], v2, s[8:11], s27 offen offset:2560 sc1
    s_mov_b64 exec, -1
    v_exp_f32 v104, v104
    v_exp_f32 v105, v105
    s_waitcnt vmcnt(9)
    v_smfmac_f32_32x32x32_bf16 v[144:159], v[68:71], v[128:135], v143
    v_exp_f32 v106, v106
    v_exp_f32 v107, v107
    v_exp_f32 v108, v108
    s_waitcnt vmcnt(8)
    v_mfma_f32_32x32x16_bf16 v[120:135], v[28:31], v[160:163], 0
    v_exp_f32 v109, v109
    v_exp_f32 v110, v110
    v_exp_f32 v111, v111
    v_exp_f32 v112, v112
    v_exp_f32 v113, v113
    s_waitcnt vmcnt(7)
    v_smfmac_f32_32x32x32_bf16 v[144:159], v[72:75], v[104:111], v143
    v_exp_f32 v114, v114
    v_exp_f32 v115, v115
    v_exp_f32 v116, v116
    v_exp_f32 v117, v117
    v_exp_f32 v118, v118
    v_exp_f32 v119, v119
    s_mov_b64 exec, s[36:37]
    buffer_load_dwordx4 v[96:99], v2, s[8:11], s27 offen offset:3072 sc1
    buffer_load_dwordx4 v[100:103], v2, s[8:11], s27 offen offset:3584 sc1
    s_mov_b64 exec, -1
    s_setprio 1
    v_mov_b32 v7, 160008
    v_mov_b32 v4, 1
    s_mov_b64 exec, 1
    ds_add_u32 v7, v4
    s_mov_b64 exec, -1
    v_exp_f32 v120, v120
    v_exp_f32 v121, v121
    s_waitcnt vmcnt(8)
    v_smfmac_f32_32x32x32_bf16 v[144:159], v[76:79], v[112:119], v143
    v_exp_f32 v122, v122
    v_exp_f32 v123, v123
    v_exp_f32 v124, v124
    s_waitcnt vmcnt(7)
    v_mfma_f32_32x32x16_bf16 v[104:119], v[32:35], v[160:163], 0
    v_exp_f32 v125, v125
    v_exp_f32 v126, v126
    v_exp_f32 v127, v127
    v_exp_f32 v128, v128
    v_exp_f32 v129, v129
    s_waitcnt vmcnt(6)
    v_smfmac_f32_32x32x32_bf16 v[144:159], v[80:83], v[120:127], v143
    v_exp_f32 v130, v130
    v_exp_f32 v131, v131
    v_exp_f32 v132, v132
    v_exp_f32 v133, v133
    v_exp_f32 v134, v134
    v_exp_f32 v135, v135
    s_mov_b32 s39, 65536
La_kv:
    ds_read_b32 v4, v7
    s_sub_u32 s39, s39, 1
    s_cbranch_scc1 La_kv_x
    s_waitcnt lgkmcnt(0)
    v_readfirstlane_b32 s33, v4
    s_cmp_ge_u32 s33, 8
    s_cbranch_scc0 La_kv
La_kv_x:
    s_waitcnt lgkmcnt(0)
    ds_read_b128 v[164:167], v6 offset:1024
    v_exp_f32 v104, v104
    v_exp_f32 v105, v105
    s_waitcnt vmcnt(5)
    v_smfmac_f32_32x32x32_bf16 v[144:159], v[84:87], v[128:135], v143
    v_exp_f32 v106, v106
    v_exp_f32 v107, v107
    v_exp_f32 v108, v108
    s_waitcnt vmcnt(4)
    v_mfma_f32_32x32x16_bf16 v[120:135], v[36:39], v[160:163], 0
    v_exp_f32 v109, v109
    v_exp_f32 v110, v110
    v_exp_f32 v111, v111
    v_exp_f32 v112, v112
    v_exp_f32 v113, v113
    s_waitcnt vmcnt(3)
    v_smfmac_f32_32x32x32_bf16 v[144:159], v[88:91], v[104:111], v143
    v_exp_f32 v114, v114
    v_exp_f32 v115, v115
    v_exp_f32 v116, v116
    v_exp_f32 v117, v117
    v_exp_f32 v118, v118
    v_exp_f32 v119, v119
    v_exp_f32 v120, v120
    v_exp_f32 v121, v121
    s_waitcnt vmcnt(2)
    v_smfmac_f32_32x32x32_bf16 v[144:159], v[92:95], v[112:119], v143
    v_exp_f32 v122, v122
    v_exp_f32 v123, v123
    v_exp_f32 v124, v124
    s_waitcnt lgkmcnt(0)
    v_mfma_f32_32x32x16_bf16 v[104:119], v[8:11], v[164:167], 0
    v_exp_f32 v125, v125
    v_exp_f32 v126, v126
    v_exp_f32 v127, v127
    v_exp_f32 v128, v128
    v_exp_f32 v129, v129
    s_waitcnt vmcnt(1)
    v_smfmac_f32_32x32x32_bf16 v[144:159], v[96:99], v[120:127], v143
    v_exp_f32 v130, v130
    v_exp_f32 v131, v131
    v_exp_f32 v132, v132
    v_exp_f32 v133, v133
    v_exp_f32 v134, v134
    v_exp_f32 v135, v135
    s_waitcnt vmcnt(0)
    s_mov_b32 s29, 3
La_loop:
    v_exp_f32 v104, v104
    v_exp_f32 v105, v105
    v_smfmac_f32_32x32x32_bf16 v[144:159], v[100:103], v[128:135], v143
    v_exp_f32 v106, v106
    v_exp_f32 v107, v107
    v_exp_f32 v108, v108
    v_mfma_f32_32x32x16_bf16 v[120:135], v[12:15], v[164:167], 0
    v_exp_f32 v109, v109
    v_exp_f32 v110, v110
    v_exp_f32 v111, v111
    v_exp_f32 v112, v112
    v_exp_f32 v113, v113
    v_exp_f32 v114, v114
    v_exp_f32 v115, v115
    v_exp_f32 v116, v116
    ds_write_b32 v5, v152 offset:1024
    v_cvt_pk_bf16_f32 v136, v144, v145
    v_cvt_pk_bf16_f32 v137, v146, v147
    v_cvt_pk_bf16_f32 v138, v148, v149
    v_cvt_pk_bf16_f32 v139, v150, v151
    ds_write_b128 v3, v[136:139] offset:0
    v_mov_b64 v[144:145], 0
    v_mov_b64 v[146:147], 0
    v_mov_b64 v[148:149], 0
    v_mov_b64 v[150:151], 0
    v_mov_b64 v[152:153], 0
    v_exp_f32 v117, v117
    v_exp_f32 v118, v118
    v_smfmac_f32_32x32x32_bf16 v[144:159], v[40:43], v[104:111], v143
    v_exp_f32 v119, v119
    v_exp_f32 v120, v120
    v_exp_f32 v121, v121
    v_smfmac_f32_32x32x32_bf16 v[144:159], v[44:47], v[112:119], v143
    v_exp_f32 v122, v122
    v_exp_f32 v123, v123
    v_exp_f32 v124, v124
    v_mfma_f32_32x32x16_bf16 v[104:119], v[16:19], v[164:167], 0
    v_exp_f32 v125, v125
    v_exp_f32 v126, v126
    v_exp_f32 v127, v127
    v_exp_f32 v128, v128
    v_exp_f32 v129, v129
    v_smfmac_f32_32x32x32_bf16 v[144:159], v[48:51], v[120:127], v143
    v_exp_f32 v130, v130
    v_exp_f32 v131, v131
    v_exp_f32 v132, v132
    v_exp_f32 v133, v133
    v_exp_f32 v134, v134
    v_exp_f32 v135, v135
    v_exp_f32 v104, v104
    v_exp_f32 v105, v105
    v_smfmac_f32_32x32x32_bf16 v[144:159], v[52:55], v[128:135], v143
    v_exp_f32 v106, v106
    v_exp_f32 v107, v107
    v_exp_f32 v108, v108
    v_mfma_f32_32x32x16_bf16 v[120:135], v[20:23], v[164:167], 0
    v_exp_f32 v109, v109
    v_exp_f32 v110, v110
    v_exp_f32 v111, v111
    v_exp_f32 v112, v112
    v_exp_f32 v113, v113
    v_smfmac_f32_32x32x32_bf16 v[144:159], v[56:59], v[104:111], v143
    v_exp_f32 v114, v114
    v_exp_f32 v115, v115
    v_exp_f32 v116, v116
    v_exp_f32 v117, v117
    v_exp_f32 v118, v118
    v_exp_f32 v119, v119
    v_exp_f32 v120, v120
    v_exp_f32 v121, v121
    v_smfmac_f32_32x32x32_bf16 v[144:159], v[60:63], v[112:119], v143
    v_exp_f32 v122, v122
    v_exp_f32 v123, v123
    v_exp_f32 v124, v124
    v_mfma_f32_32x32x16_bf16 v[104:119], v[24:27], v[164:167], 0
    v_exp_f32 v125, v125
    v_exp_f32 v126, v126
    v_exp_f32 v127, v127
    v_exp_f32 v128, v128
    v_exp_f32 v129, v129
    v_smfmac_f32_32x32x32_bf16 v[144:159], v[64:67], v[120:127], v143
    v_exp_f32 v130, v130
    v_exp_f32 v131, v131
    v_exp_f32 v132, v132
    v_exp_f32 v133, v133
    v_exp_f32 v134, v134
    v_exp_f32 v135, v135
    v_exp_f32 v104, v104
    v_exp_f32 v105, v105
    v_smfmac_f32_32x32x32_bf16 v[144:159], v[68:71], v[128:135], v143
    v_exp_f32 v106, v106
    v_exp_f32 v107, v107
    v_exp_f32 v108, v108
    v_mfma_f32_32x32x16_bf16 v[120:135], v[28:31], v[164:167], 0
    v_exp_f32 v109, v109
    v_exp_f32 v110, v110
    v_exp_f32 v111, v111
    v_exp_f32 v112, v112
    v_exp_f32 v113, v113
    v_smfmac_f32_32x32x32_bf16 v[144:159], v[72:75], v[104:111], v143
    v_exp_f32 v114, v114
    v_exp_f32 v115, v115
    v_exp_f32 v116, v116
    v_exp_f32 v117, v117
    v_exp_f32 v118, v118
    v_exp_f32 v119, v119
    ds_read_b128 v[160:163], v6 offset:2048
    v_exp_f32 v120, v120
    v_exp_f32 v121, v121
    v_smfmac_f32_32x32x32_bf16 v[144:159], v[76:79], v[112:119], v143
    v_exp_f32 v122, v122
    v_exp_f32 v123, v123
    v_exp_f32 v124, v124
    v_mfma_f32_32x32x16_bf16 v[104:119], v[32:35], v[164:167], 0
    v_exp_f32 v125, v125
    v_exp_f32 v126, v126
    v_exp_f32 v127, v127
    v_exp_f32 v128, v128
    v_exp_f32 v129, v129
    v_smfmac_f32_32x32x32_bf16 v[144:159], v[80:83], v[120:127], v143
    v_exp_f32 v130, v130
    v_exp_f32 v131, v131
    v_exp_f32 v132, v132
    v_exp_f32 v133, v133
    v_exp_f32 v134, v134
    v_exp_f32 v135, v135
    v_exp_f32 v104, v104
    v_exp_f32 v105, v105
    v_smfmac_f32_32x32x32_bf16 v[144:159], v[84:87], v[128:135], v143
    v_exp_f32 v106, v106
    v_exp_f32 v107, v107
    v_exp_f32 v108, v108
    v_mfma_f32_32x32x16_bf16 v[120:135], v[36:39], v[164:167], 0
    v_exp_f32 v109, v109
    v_exp_f32 v110, v110
    v_exp_f32 v111, v111
    v_exp_f32 v112, v112
    v_exp_f32 v113, v113
    v_smfmac_f32_32x32x32_bf16 v[144:159], v[88:91], v[104:111], v143
    v_exp_f32 v114, v114
    v_exp_f32 v115, v115
    v_exp_f32 v116, v116
    v_exp_f32 v117, v117
    v_exp_f32 v118, v118
    v_exp_f32 v119, v119
    v_exp_f32 v120, v120
    v_exp_f32 v121, v121
    v_smfmac_f32_32x32x32_bf16 v[144:159], v[92:95], v[112:119], v143
    v_exp_f32 v122, v122
    v_exp_f32 v123, v123
    v_exp_f32 v124, v124
    s_waitcnt lgkmcnt(0)
    v_mfma_f32_32x32x16_bf16 v[104:119], v[8:11], v[160:163], 0
    v_exp_f32 v125, v125
    v_exp_f32 v126, v126
    v_exp_f32 v127, v127
    v_exp_f32 v128, v128
    v_exp_f32 v129, v129
    v_smfmac_f32_32x32x32_bf16 v[144:159], v[96:99], v[120:127], v143
    v_exp_f32 v130, v130
    v_exp_f32 v131, v131
    v_exp_f32 v132, v132
    v_exp_f32 v133, v133
    v_exp_f32 v134, v134
    v_exp_f32 v135, v135
    v_exp_f32 v104, v104
    v_exp_f32 v105, v105
    v_smfmac_f32_32x32x32_bf16 v[144:159], v[100:103], v[128:135], v143
    v_exp_f32 v106, v106
    v_exp_f32 v107, v107
    v_exp_f32 v108, v108
    v_mfma_f32_32x32x16_bf16 v[120:135], v[12:15], v[160:163], 0
    v_exp_f32 v109, v109
    v_exp_f32 v110, v110
    v_exp_f32 v111, v111
    v_exp_f32 v112, v112
    v_exp_f32 v113, v113
    v_exp_f32 v114, v114
    v_exp_f32 v115, v115
    v_exp_f32 v116, v116
    ds_write_b32 v5, v152 offset:10240
    v_cvt_pk_bf16_f32 v136, v144, v145
    v_cvt_pk_bf16_f32 v137, v146, v147
    v_cvt_pk_bf16_f32 v138, v148, v149
    v_cvt_pk_bf16_f32 v139, v150, v151
    ds_write_b128 v3, v[136:139] offset:9216
    v_mov_b64 v[144:145], 0
    v_mov_b64 v[146:147], 0
    v_mov_b64 v[148:149], 0
    v_mov_b64 v[150:151], 0
    v_mov_b64 v[152:153], 0
    v_exp_f32 v117, v117
    v_exp_f32 v118, v118
    v_smfmac_f32_32x32x32_bf16 v[144:159], v[40:43], v[104:111], v143
    v_exp_f32 v119, v119
    v_exp_f32 v120, v120
    v_exp_f32 v121, v121
    v_smfmac_f32_32x32x32_bf16 v[144:159], v[44:47], v[112:119], v143
    v_exp_f32 v122, v122
    v_exp_f32 v123, v123
    v_exp_f32 v124, v124
    v_mfma_f32_32x32x16_bf16 v[104:119], v[16:19], v[160:163], 0
    v_exp_f32 v125, v125
    v_exp_f32 v126, v126
    v_exp_f32 v127, v127
    v_exp_f32 v128, v128
    v_exp_f32 v129, v129
    v_smfmac_f32_32x32x32_bf16 v[144:159], v[48:51], v[120:127], v143
    v_exp_f32 v130, v130
    v_exp_f32 v131, v131
    v_exp_f32 v132, v132
    v_exp_f32 v133, v133
    v_exp_f32 v134, v134
    v_exp_f32 v135, v135
    v_exp_f32 v104, v104
    v_exp_f32 v105, v105
    v_smfmac_f32_32x32x32_bf16 v[144:159], v[52:55], v[128:135], v143
    v_exp_f32 v106, v106
    v_exp_f32 v107, v107
    v_exp_f32 v108, v108
    v_mfma_f32_32x32x16_bf16 v[120:135], v[20:23], v[160:163], 0
    v_exp_f32 v109, v109
    v_exp_f32 v110, v110
    v_exp_f32 v111, v111
    v_exp_f32 v112, v112
    v_exp_f32 v113, v113
    v_smfmac_f32_32x32x32_bf16 v[144:159], v[56:59], v[104:111], v143
    v_exp_f32 v114, v114
    v_exp_f32 v115, v115
    v_exp_f32 v116, v116
    v_exp_f32 v117, v117
    v_exp_f32 v118, v118
    v_exp_f32 v119, v119
    v_exp_f32 v120, v120
    v_exp_f32 v121, v121
    v_smfmac_f32_32x32x32_bf16 v[144:159], v[60:63], v[112:119], v143
    v_exp_f32 v122, v122
    v_exp_f32 v123, v123
    v_exp_f32 v124, v124
    v_mfma_f32_32x32x16_bf16 v[104:119], v[24:27], v[160:163], 0
    v_exp_f32 v125, v125
    v_exp_f32 v126, v126
    v_exp_f32 v127, v127
    v_exp_f32 v128, v128
    v_exp_f32 v129, v129
    v_smfmac_f32_32x32x32_bf16 v[144:159], v[64:67], v[120:127], v143
    v_exp_f32 v130, v130
    v_exp_f32 v131, v131
    v_exp_f32 v132, v132
    v_exp_f32 v133, v133
    v_exp_f32 v134, v134
    v_exp_f32 v135, v135
    v_exp_f32 v104, v104
    v_exp_f32 v105, v105
    v_smfmac_f32_32x32x32_bf16 v[144:159], v[68:71], v[128:135], v143
    v_exp_f32 v106, v106
    v_exp_f32 v107, v107
    v_exp_f32 v108, v108
    v_mfma_f32_32x32x16_bf16 v[120:135], v[28:31], v[160:163], 0
    v_exp_f32 v109, v109
    v_exp_f32 v110, v110
    v_exp_f32 v111, v111
    v_exp_f32 v112, v112
    v_exp_f32 v113, v113
    v_smfmac_f32_32x32x32_bf16 v[144:159], v[72:75], v[104:111], v143
    v_exp_f32 v114, v114
    v_exp_f32 v115, v115
    v_exp_f32 v116, v116
    v_exp_f32 v117, v117
    v_exp_f32 v118, v118
    v_exp_f32 v119, v119
    ds_read_b128 v[164:167], v6 offset:3072
    v_exp_f32 v120, v120
    v_exp_f32 v121, v121
    v_smfmac_f32_32x32x32_bf16 v[144:159], v[76:79], v[112:119], v143
    v_exp_f32 v122, v122
    v_exp_f32 v123, v123
    v_exp_f32 v124, v124
    v_mfma_f32_32x32x16_bf16 v[104:119], v[32:35], v[160:163], 0
    v_exp_f32 v125, v125
    v_exp_f32 v126, v126
    v_exp_f32 v127, v127
    v_exp_f32 v128, v128
    v_exp_f32 v129, v129
    v_smfmac_f32_32x32x32_bf16 v[144:159], v[80:83], v[120:127], v143
    v_exp_f32 v130, v130
    v_exp_f32 v131, v131
    v_exp_f32 v132, v132
    v_exp_f32 v133, v133
    v_exp_f32 v134, v134
    v_exp_f32 v135, v135
    v_exp_f32 v104, v104
    v_exp_f32 v105, v105
    v_smfmac_f32_32x32x32_bf16 v[144:159], v[84:87], v[128:135], v143
    v_exp_f32 v106, v106
    v_exp_f32 v107, v107
    v_exp_f32 v108, v108
    v_mfma_f32_32x32x16_bf16 v[120:135], v[36:39], v[160:163], 0
    v_exp_f32 v109, v109
    v_exp_f32 v110, v110
    v_exp_f32 v111, v111
    v_exp_f32 v112, v112
    v_exp_f32 v113, v113
    v_smfmac_f32_32x32x32_bf16 v[144:159], v[88:91], v[104:111], v143
    v_exp_f32 v114, v114
    v_exp_f32 v115, v115
    v_exp_f32 v116, v116
    v_exp_f32 v117, v117
    v_exp_f32 v118, v118
    v_exp_f32 v119, v119
    v_exp_f32 v120, v120
    v_exp_f32 v121, v121
    v_smfmac_f32_32x32x32_bf16 v[144:159], v[92:95], v[112:119], v143
    v_exp_f32 v122, v122
    v_exp_f32 v123, v123
    v_exp_f32 v124, v124
    s_waitcnt lgkmcnt(0)
    v_mfma_f32_32x32x16_bf16 v[104:119], v[8:11], v[164:167], 0
    v_exp_f32 v125, v125
    v_exp_f32 v126, v126
    v_exp_f32 v127, v127
    v_exp_f32 v128, v128
    v_exp_f32 v129, v129
    v_smfmac_f32_32x32x32_bf16 v[144:159], v[96:99], v[120:127], v143
    v_exp_f32 v130, v130
    v_exp_f32 v131, v131
    v_exp_f32 v132, v132
    v_exp_f32 v133, v133
    v_exp_f32 v134, v134
    v_exp_f32 v135, v135
    v_add_u32 v3, 18432, v3
    v_add_u32 v5, 18432, v5
    v_add_u32 v6, 2048, v6
    s_sub_u32 s29, s29, 1
    s_cmp_lg_u32 s29, 0
    s_cbranch_scc1 La_loop
    s_cmp_lt_u32 s20, 4
    s_cbranch_scc0 La_lp
    s_setprio 0
La_lp:
    s_lshl_b32 s33, s31, 3
    s_or_b32 s33, s33, s20
    s_and_b32 s33, s33, 255
    s_cmp_eq_u32 s33, 0
    s_cbranch_scc0 La_nwb
    buffer_wbl2 sc1
La_nwb:
    v_exp_f32 v104, v104
    v_exp_f32 v105, v105
    v_smfmac_f32_32x32x32_bf16 v[144:159], v[100:103], v[128:135], v143
    v_exp_f32 v106, v106
    v_exp_f32 v107, v107
    v_exp_f32 v108, v108
    v_mfma_f32_32x32x16_bf16 v[120:135], v[12:15], v[164:167], 0
    v_exp_f32 v109, v109
    v_exp_f32 v110, v110
    v_exp_f32 v111, v111
    v_exp_f32 v112, v112
    v_exp_f32 v113, v113
    v_exp_f32 v114, v114
    v_exp_f32 v115, v115
    v_exp_f32 v116, v116
    ds_write_b32 v5, v152 offset:1024
    v_cvt_pk_bf16_f32 v136, v144, v145
    v_cvt_pk_bf16_f32 v137, v146, v147
    v_cvt_pk_bf16_f32 v138, v148, v149
    v_cvt_pk_bf16_f32 v139, v150, v151
    ds_write_b128 v3, v[136:139] offset:0
    v_mov_b64 v[144:145], 0
    v_mov_b64 v[146:147], 0
    v_mov_b64 v[148:149], 0
    v_mov_b64 v[150:151], 0
    v_mov_b64 v[152:153], 0
    v_exp_f32 v117, v117
    v_exp_f32 v118, v118
    v_smfmac_f32_32x32x32_bf16 v[144:159], v[40:43], v[104:111], v143
    v_exp_f32 v119, v119
    v_exp_f32 v120, v120
    v_exp_f32 v121, v121
    v_smfmac_f32_32x32x32_bf16 v[144:159], v[44:47], v[112:119], v143
    v_exp_f32 v122, v122
    v_exp_f32 v123, v123
    v_exp_f32 v124, v124
    v_mfma_f32_32x32x16_bf16 v[104:119], v[16:19], v[164:167], 0
    v_exp_f32 v125, v125
    v_exp_f32 v126, v126
    v_exp_f32 v127, v127
    v_exp_f32 v128, v128
    v_exp_f32 v129, v129
    v_smfmac_f32_32x32x32_bf16 v[144:159], v[48:51], v[120:127], v143
    v_exp_f32 v130, v130
    v_exp_f32 v131, v131
    v_exp_f32 v132, v132
    v_exp_f32 v133, v133
    v_exp_f32 v134, v134
    v_exp_f32 v135, v135
    v_exp_f32 v104, v104
    v_exp_f32 v105, v105
    v_smfmac_f32_32x32x32_bf16 v[144:159], v[52:55], v[128:135], v143
    v_exp_f32 v106, v106
    v_exp_f32 v107, v107
    v_exp_f32 v108, v108
    v_mfma_f32_32x32x16_bf16 v[120:135], v[20:23], v[164:167], 0
    v_exp_f32 v109, v109
    v_exp_f32 v110, v110
    v_exp_f32 v111, v111
    v_exp_f32 v112, v112
    v_exp_f32 v113, v113
    v_smfmac_f32_32x32x32_bf16 v[144:159], v[56:59], v[104:111], v143
    v_exp_f32 v114, v114
    v_exp_f32 v115, v115
    v_exp_f32 v116, v116
    v_exp_f32 v117, v117
    v_exp_f32 v118, v118
    v_exp_f32 v119, v119
    v_exp_f32 v120, v120
    v_exp_f32 v121, v121
    v_smfmac_f32_32x32x32_bf16 v[144:159], v[60:63], v[112:119], v143
    v_exp_f32 v122, v122
    v_exp_f32 v123, v123
    v_exp_f32 v124, v124
    v_mfma_f32_32x32x16_bf16 v[104:119], v[24:27], v[164:167], 0
    v_exp_f32 v125, v125
    v_exp_f32 v126, v126
    v_exp_f32 v127, v127
    v_exp_f32 v128, v128
    v_exp_f32 v129, v129
    v_smfmac_f32_32x32x32_bf16 v[144:159], v[64:67], v[120:127], v143
    v_exp_f32 v130, v130
    v_exp_f32 v131, v131
    v_exp_f32 v132, v132
    v_exp_f32 v133, v133
    v_exp_f32 v134, v134
    v_exp_f32 v135, v135
    v_exp_f32 v104, v104
    v_exp_f32 v105, v105
    v_smfmac_f32_32x32x32_bf16 v[144:159], v[68:71], v[128:135], v143
    v_exp_f32 v106, v106
    v_exp_f32 v107, v107
    v_exp_f32 v108, v108
    v_mfma_f32_32x32x16_bf16 v[120:135], v[28:31], v[164:167], 0
    v_exp_f32 v109, v109
    v_exp_f32 v110, v110
    v_exp_f32 v111, v111
    v_exp_f32 v112, v112
    v_exp_f32 v113, v113
    v_smfmac_f32_32x32x32_bf16 v[144:159], v[72:75], v[104:111], v143
    v_exp_f32 v114, v114
    v_exp_f32 v115, v115
    v_exp_f32 v116, v116
    v_exp_f32 v117, v117
    v_exp_f32 v118, v118
    v_exp_f32 v119, v119
    v_exp_f32 v120, v120
    v_exp_f32 v121, v121
    v_smfmac_f32_32x32x32_bf16 v[144:159], v[76:79], v[112:119], v143
    v_exp_f32 v122, v122
    v_exp_f32 v123, v123
    v_exp_f32 v124, v124
    v_mfma_f32_32x32x16_bf16 v[104:119], v[32:35], v[164:167], 0
    v_exp_f32 v125, v125
    v_exp_f32 v126, v126
    v_exp_f32 v127, v127
    v_exp_f32 v128, v128
    v_exp_f32 v129, v129
    v_smfmac_f32_32x32x32_bf16 v[144:159], v[80:83], v[120:127], v143
    v_exp_f32 v130, v130
    v_exp_f32 v131, v131
    v_exp_f32 v132, v132
    v_exp_f32 v133, v133
    v_exp_f32 v134, v134
    v_exp_f32 v135, v135
    v_exp_f32 v104, v104
    v_exp_f32 v105, v105
    v_smfmac_f32_32x32x32_bf16 v[144:159], v[84:87], v[128:135], v143
    v_exp_f32 v106, v106
    v_exp_f32 v107, v107
    v_exp_f32 v108, v108
    v_mfma_f32_32x32x16_bf16 v[120:135], v[36:39], v[164:167], 0
    v_exp_f32 v109, v109
    v_exp_f32 v110, v110
    v_exp_f32 v111, v111
    v_exp_f32 v112, v112
    v_exp_f32 v113, v113
    v_smfmac_f32_32x32x32_bf16 v[144:159], v[88:91], v[104:111], v143
    v_exp_f32 v114, v114
    v_exp_f32 v115, v115
    v_exp_f32 v116, v116
    v_exp_f32 v117, v117
    v_exp_f32 v118, v118
    v_exp_f32 v119, v119
    v_exp_f32 v120, v120
    v_exp_f32 v121, v121
    v_smfmac_f32_32x32x32_bf16 v[144:159], v[92:95], v[112:119], v143
    v_exp_f32 v122, v122
    v_exp_f32 v123, v123
    v_exp_f32 v124, v124
    v_exp_f32 v125, v125
    v_exp_f32 v126, v126
    v_exp_f32 v127, v127
    v_exp_f32 v128, v128
    v_exp_f32 v129, v129
    v_smfmac_f32_32x32x32_bf16 v[144:159], v[96:99], v[120:127], v143
    v_exp_f32 v130, v130
    v_exp_f32 v131, v131
    v_exp_f32 v132, v132
    v_exp_f32 v133, v133
    v_exp_f32 v134, v134
    v_exp_f32 v135, v135
    s_setprio 3
    s_nop 0
    v_smfmac_f32_32x32x32_bf16 v[144:159], v[100:103], v[128:135], v143
    v_and_b32 v7, 31, v0
    v_and_b32 v160, 3, v0
    v_cmp_eq_u32 vcc, 3, v160
    v_bfe_u32 v4, v0, 2, 1
    v_bfe_u32 v6, v0, 3, 1
    v_cndmask_b32 v160, v160, 0, vcc
    v_lshl_or_b32 v4, v4, 1, v6
    v_bfe_u32 v6, v0, 4, 1
    v_lshl_or_b32 v4, v6, 2, v4
    v_or_b32 v160, 12, v160
    v_mul_u32_u24 v142, 0x1111, v160
    v_mov_b32 v6, 0x3f80
    v_mov_b32 v160, 1.0
    v_cndmask_b32 v6, v6, v160, vcc
    v_cvt_pk_bf16_f32 v104, v144, v145
    v_cvt_pk_bf16_f32 v105, v146, v147
    v_cvt_pk_bf16_f32 v106, v148, v149
    v_cvt_pk_bf16_f32 v107, v150, v151
    ds_write_b32 v5, v152 offset:10240
    ds_write_b128 v3, v[104:107] offset:9216
    v_mov_b32 v160, 160024
    v_mov_b32 v161, 1
    s_mov_b64 exec, 1
    ds_add_u32 v160, v161
    s_mov_b64 exec, -1
    v_cmp_eq_u32 s[40:41], 0, v4
    v_cmp_eq_u32 s[42:43], 1, v4
    v_cmp_eq_u32 s[44:45], 2, v4
    v_cmp_eq_u32 s[46:47], 3, v4
    s_lshl_b32 s33, s22, 3
    s_add_u32 s38, s33, s20
    s_lshl_b32 s34, s38, 15
    s_lshl_b32 s35, s21, 10
    s_add_u32 s34, s34, s35
    s_add_u32 s34, s34, 6291456
    s_mul_i32 s35, s20, 9216
    v_add_u32 v3, s35, v1
    v_lshl_add_u32 v5, v7, 2, s35
    v_cndmask_b32 v164, 0, v6, s[40:41]
    v_cndmask_b32 v165, 0, v6, s[42:43]
    v_cndmask_b32 v166, 0, v6, s[44:45]
    v_cndmask_b32 v167, 0, v6, s[46:47]
    v_mov_b64 v[144:145], 0
    v_mov_b64 v[146:147], 0
    v_mov_b64 v[148:149], 0
    v_mov_b64 v[150:151], 0
    s_mov_b32 s39, 65536
La_fin:
    ds_read_b32 v161, v160
    s_sub_u32 s39, s39, 1
    s_cbranch_scc1 La_fin_x
    s_waitcnt lgkmcnt(0)
    v_readfirstlane_b32 s33, v161
    s_cmp_ge_u32 s33, 8
    s_cbranch_scc0 La_fin
La_fin_x:
    s_waitcnt lgkmcnt(0)
    ds_read_b128 v[8:11], v3 offset:0
    ds_read_b128 v[12:15], v3 offset:1152
    ds_read_b128 v[16:19], v3 offset:2304
    ds_read_b128 v[20:23], v3 offset:3456
    ds_read_b32 v104, v5 offset:1024
    ds_read_b32 v105, v5 offset:2176
    ds_read_b32 v106, v5 offset:3328
    ds_read_b32 v107, v5 offset:4480
    ds_read_b32 v108, v5 offset:5632
    ds_read_b32 v109, v5 offset:6784
    ds_read_b32 v110, v5 offset:7936
    ds_read_b32 v111, v5 offset:9088
    ds_read_b128 v[24:27], v3 offset:4608
    ds_read_b128 v[28:31], v3 offset:5760
    ds_read_b128 v[32:35], v3 offset:6912
    ds_read_b128 v[36:39], v3 offset:8064
    s_waitcnt lgkmcnt(14)
    v_smfmac_f32_32x32x32_bf16 v[144:159], v[164:167], v[8:15], v142
    s_waitcnt lgkmcnt(12)
    v_smfmac_f32_32x32x32_bf16 v[144:159], v[164:167], v[16:23], v142
    s_waitcnt lgkmcnt(2)
    v_smfmac_f32_32x32x32_bf16 v[144:159], v[164:167], v[24:31], v142
    v_add_f32 v104, v104, v108
    v_add_f32 v105, v105, v109
    v_add_f32 v106, v106, v110
    v_add_f32 v107, v107, v111
    v_add_f32 v104, v104, v105
    v_add_f32 v106, v106, v107
    v_add_f32 v104, v104, v106
    v_cmp_le_f32 vcc, 0x1f800000, v104
    s_mov_b64 s[40:41], vcc
    v_cmp_ge_f32 vcc, 0x5f800000, v104
    v_rcp_f32 v7, v104
    s_and_b64 s[40:41], s[40:41], vcc
    s_waitcnt lgkmcnt(0)
    v_smfmac_f32_32x32x32_bf16 v[144:159], v[164:167], v[32:39], v142
    s_nop 11
    v_mul_f32 v144, v7, v144
    v_mul_f32 v145, v7, v145
    v_mul_f32 v146, v7, v146
    v_mul_f32 v147, v7, v147
    v_mul_f32 v148, v7, v148
    v_mul_f32 v149, v7, v149
    v_mul_f32 v150, v7, v150
    v_mul_f32 v151, v7, v151
    v_cvt_pk_bf16_f32 v136, v144, v145
    v_cvt_pk_bf16_f32 v137, v146, v147
    v_cvt_pk_bf16_f32 v138, v148, v149
    v_cvt_pk_bf16_f32 v139, v150, v151
    buffer_store_dwordx4 v[136:139], v1, s[8:11], s34 offen sc1
    v_mul_f32 v4, 0, v144
    v_fmac_f32 v4, 0, v145
    v_fmac_f32 v4, 0, v146
    v_fmac_f32 v4, 0, v147
    v_fmac_f32 v4, 0, v148
    v_fmac_f32 v4, 0, v149
    v_fmac_f32 v4, 0, v150
    v_fmac_f32 v4, 0, v151
    v_cmp_eq_f32 vcc, 0, v4
    s_and_b64 s[40:41], s[40:41], vcc
    s_cmp_eq_u64 s[40:41], -1
    s_cbranch_scc0 La_slow
La_st:
    s_lshl_b32 s43, s30, 2
    s_and_b32 s33, s31, 3
    s_add_u32 s43, s43, s33
    s_lshr_b32 s44, s31, 2
    s_lshl_b32 s45, s20, 16
    s_lshl_b32 s33, s44, 7
    s_add_u32 s45, s45, s33
    v_lshrrev_b32 v4, 3, v0
    v_lshlrev_b32 v4, 10, v4
    v_and_b32 v5, 7, v0
    v_bfe_u32 v6, v0, 4, 1
    v_lshlrev_b32 v6, 2, v6
    v_xor_b32 v5, v5, v6
    v_lshl_add_u32 v4, v5, 4, v4
    s_mov_b32 m0, s35
    s_mov_b32 s29, 8
    v_and_b32 v103, 7, v0
    v_lshlrev_b32 v103, 4, v103
    s_lshl_b32 s33, s43, 1
    s_and_b32 s46, s20, 1
    s_add_u32 s33, s33, s46
    s_lshl_b32 s33, s33, 2
    s_lshr_b32 s47, s20, 1
    s_add_u32 s33, s33, s47
    s_lshl_b32 s33, s33, 7
    s_add_u32 s42, s33, 12857344
    s_lshl_b32 s33, s38, 9
    s_lshl_b32 s46, s21, 4
    s_add_u32 s33, s33, s46
    s_add_u32 s33, s33, 12857344
    v_mov_b32 v5, s7
    s_waitcnt vmcnt(0)
    s_mov_b64 exec, 1
    buffer_store_dword v5, v1, s[8:11], s33 offen sc1
    s_mov_b64 exec, -1
    s_setprio 3
    v_mov_b32 v6, 160020
    v_mov_b32 v7, 1
    s_mov_b64 exec, 1
    ds_add_u32 v6, v7
    s_mov_b64 exec, -1
    s_mov_b32 s39, 65536
Lo_hd:
    ds_read_b32 v7, v6
    s_sub_u32 s39, s39, 1
    s_cbranch_scc1 Lo_hd_x
    s_waitcnt lgkmcnt(0)
    v_readfirstlane_b32 s33, v7
    s_cmp_ge_u32 s33, 8
    s_cbranch_scc1 Lo_hd_x
    s_sleep 1
    s_branch Lo_hd
Lo_hd_x:
    s_waitcnt lgkmcnt(0)
Lo_wd:
    buffer_load_dwordx4 v4, s[12:15], s45 offen lds
    s_add_u32 m0, m0, 1024
    s_add_u32 s45, s45, 8192
    s_sub_u32 s29, s29, 1
    s_cmp_lg_u32 s29, 0
    s_cbranch_scc1 Lo_wd
    buffer_load_dword v7, v103, s[8:11], s42 offen sc1
    s_and_b32 s46, s20, 1
    s_lshr_b32 s47, s20, 1
    s_lshl_b32 s33, s43, 1
    s_add_u32 s33, s33, s46
    s_lshl_b32 s24, s33, 15
    s_lshl_b32 s45, s47, 13
    s_add_u32 s24, s24, s45
    s_add_u32 s24, s24, 6291456
    s_add_u32 s25, s24, 4096
    s_lshl_b32 s26, s33, 17
    s_and_b32 s48, s47, 1
    s_lshl_b32 s33, s44, 1
    s_add_u32 s33, s33, s48
    s_lshl_b32 s33, s33, 7
    s_add_u32 s26, s26, s33
    s_lshr_b32 s49, s47, 1
    s_lshl_b32 s45, s49, 16
    s_add_u32 s26, s26, s45
    s_add_u32 s26, s26, 2048
    s_add_u32 s27, s26, 32768
    v_lshrrev_b32 v2, 5, v0
    v_lshlrev_b32 v5, 2, v2
    v_bfe_u32 v6, v0, 2, 2
    v_add_lshl_u32 v5, v5, v6, 7
    v_bfe_u32 v6, v0, 3, 1
    v_lshl_add_u32 v5, v6, 6, v5
    v_bfe_u32 v6, v0, 4, 1
    v_lshl_add_u32 v5, v6, 5, v5
    v_and_b32 v6, 3, v0
    v_lshl_add_u32 v5, v6, 3, v5
    s_mul_i32 s33, s47, 18432
    v_xor_b32 v6, 64, v5
    v_add_u32 v5, s33, v5
    v_add_u32 v6, s33, v6
    s_lshl_b32 s33, s20, 13
    s_add_u32 s50, s33, 0
    s_lshl_b32 s33, s46, 13
    s_lshl_b32 s45, s48, 12
    s_add_u32 s33, s33, s45
    s_lshl_b32 s45, s49, 11
    s_add_u32 s33, s33, s45
    s_add_u32 s51, s33, 0
    v_lshrrev_b32 v2, 5, v0
    v_and_b32 v3, 7, v0
    v_xor_b32 v2, v2, v3
    v_lshlrev_b32 v2, 4, v2
    v_and_b32 v3, 31, v0
    v_lshl_add_u32 v2, v3, 7, v2
    v_xor_b32 v3, 0, v2
    v_add_u32 v96, s50, v3
    v_xor_b32 v3, 32, v2
    v_add_u32 v97, s50, v3
    v_xor_b32 v3, 64, v2
    v_add_u32 v98, s50, v3
    v_xor_b32 v3, 96, v2
    v_add_u32 v99, s50, v3
    v_lshrrev_b32 v2, 3, v0
    v_and_b32 v101, 7, v0
    v_xor_b32 v100, v2, v101
    v_lshlrev_b32 v100, 4, v100
    v_lshl_add_u32 v100, v2, 7, v100
    v_add_u32 v100, s51, v100
    v_lshlrev_b32 v101, 4, v101
    v_lshl_add_u32 v101, v2, 12, v101
    v_mov_b64 v[64:65], 0
    v_mov_b64 v[66:67], 0
    v_mov_b64 v[68:69], 0
    v_mov_b64 v[70:71], 0
    v_mov_b64 v[72:73], 0
    v_mov_b64 v[74:75], 0
    v_mov_b64 v[76:77], 0
    v_mov_b64 v[78:79], 0
    v_mov_b64 v[80:81], 0
    v_mov_b64 v[82:83], 0
    v_mov_b64 v[84:85], 0
    v_mov_b64 v[86:87], 0
    v_mov_b64 v[88:89], 0
    v_mov_b64 v[90:91], 0
    v_mov_b64 v[92:93], 0
    v_mov_b64 v[94:95], 0
    v_mov_b32 v4, v103
    s_mov_b32 s45, s42
    s_waitcnt vmcnt(0)
    v_mov_b32 v2, 160028
    v_mov_b32 v3, 1
    s_mov_b64 exec, 1
    ds_add_u32 v2, v3
    s_mov_b64 exec, -1
    v_cmp_eq_u32 vcc, s7, v7
    s_and_b32 s29, vcc_lo, 0xff
    s_mov_b32 s28, s29
    s_bitcmp1_b32 s29, 0
    s_cbranch_scc0 Lo_e0
    buffer_load_dwordx4 v[8:11], v1, s[8:11], s24 offen offset:0 sc1
Lo_e0:
    s_bitcmp1_b32 s29, 1
    s_cbranch_scc0 Lo_e1
    buffer_load_dwordx4 v[12:15], v1, s[8:11], s24 offen offset:1024 sc1
Lo_e1:
    s_bitcmp1_b32 s29, 2
    s_cbranch_scc0 Lo_e2
    buffer_load_dwordx4 v[16:19], v1, s[8:11], s24 offen offset:2048 sc1
Lo_e2:
    s_bitcmp1_b32 s29, 3
    s_cbranch_scc0 Lo_e3
    buffer_load_dwordx4 v[20:23], v1, s[8:11], s24 offen offset:3072 sc1
Lo_e3:
    s_bitcmp1_b32 s29, 4
    s_cbranch_scc0 Lo_e4
    buffer_load_dwordx4 v[24:27], v1, s[8:11], s25 offen offset:0 sc1
Lo_e4:
    s_bitcmp1_b32 s29, 5
    s_cbranch_scc0 Lo_e5
    buffer_load_dwordx4 v[28:31], v1, s[8:11], s25 offen offset:1024 sc1
Lo_e5:
    s_bitcmp1_b32 s29, 6
    s_cbranch_scc0 Lo_e6
    buffer_load_dwordx4 v[32:35], v1, s[8:11], s25 offen offset:2048 sc1
Lo_e6:
    s_bitcmp1_b32 s29, 7
    s_cbranch_scc0 Lo_e7
    buffer_load_dwordx4 v[36:39], v1, s[8:11], s25 offen offset:3072 sc1
Lo_e7:
    buffer_load_dword v7, v4, s[8:11], s45 offen sc1
    s_mov_b32 s39, 65536
Lo_ow:
    ds_read_b32 v3, v2
    s_sub_u32 s39, s39, 1
    s_cbranch_scc1 Lo_ow_x
    s_waitcnt lgkmcnt(0)
    v_readfirstlane_b32 s33, v3
    s_cmp_ge_u32 s33, 8
    s_cbranch_scc1 Lo_ow_x
    s_sleep 1
    s_branch Lo_ow
Lo_ow_x:
    s_waitcnt lgkmcnt(0)
    ds_read_b64_tr_b16 v[104:105], v5 offset:0
    ds_read_b64_tr_b16 v[106:107], v5 offset:1024
    ds_read_b64_tr_b16 v[108:109], v6 offset:0
    ds_read_b64_tr_b16 v[110:111], v6 offset:1024
    ds_read_b64_tr_b16 v[112:113], v5 offset:2048
    ds_read_b64_tr_b16 v[114:115], v5 offset:3072
    ds_read_b64_tr_b16 v[116:117], v6 offset:2048
    ds_read_b64_tr_b16 v[118:119], v6 offset:3072
    ds_read_b64_tr_b16 v[120:121], v5 offset:4096
    ds_read_b64_tr_b16 v[122:123], v5 offset:5120
    ds_read_b64_tr_b16 v[124:125], v6 offset:4096
    ds_read_b64_tr_b16 v[126:127], v6 offset:5120
    ds_read_b64_tr_b16 v[128:129], v5 offset:6144
    ds_read_b64_tr_b16 v[130:131], v5 offset:7168
    ds_read_b64_tr_b16 v[132:133], v6 offset:6144
    ds_read_b64_tr_b16 v[134:135], v6 offset:7168
    ds_read_b64_tr_b16 v[136:137], v5 offset:9216
    ds_read_b64_tr_b16 v[138:139], v5 offset:10240
    ds_read_b64_tr_b16 v[140:141], v6 offset:9216
    ds_read_b64_tr_b16 v[142:143], v6 offset:10240
    ds_read_b64_tr_b16 v[144:145], v5 offset:11264
    ds_read_b64_tr_b16 v[146:147], v5 offset:12288
    ds_read_b64_tr_b16 v[148:149], v6 offset:11264
    ds_read_b64_tr_b16 v[150:151], v6 offset:12288
    ds_read_b64_tr_b16 v[152:153], v5 offset:13312
    ds_read_b64_tr_b16 v[154:155], v5 offset:14336
    ds_read_b64_tr_b16 v[156:157], v6 offset:13312
    ds_read_b64_tr_b16 v[158:159], v6 offset:14336
    ds_read_b64_tr_b16 v[160:161], v5 offset:15360
    ds_read_b64_tr_b16 v[162:163], v5 offset:16384
    ds_read_b64_tr_b16 v[164:165], v6 offset:15360
    ds_read_b64_tr_b16 v[166:167], v6 offset:16384
    s_waitcnt lgkmcnt(0)
    v_mov_b32 v2, 160036
    v_mov_b32 v3, 1
    s_mov_b64 exec, 1
    ds_add_u32 v2, v3
    s_mov_b64 exec, -1
    s_waitcnt vmcnt(1) lgkmcnt(0)
    s_bitcmp1_b32 s29, 0
    s_cbranch_scc0 Lo_f0
    v_mfma_f32_32x32x16_bf16 v[64:79], v[104:107], v[8:11], v[64:79]
    v_mfma_f32_32x32x16_bf16 v[80:95], v[108:111], v[8:11], v[80:95]
Lo_f0:
    s_bitcmp1_b32 s29, 1
    s_cbranch_scc0 Lo_f1
    v_mfma_f32_32x32x16_bf16 v[64:79], v[112:115], v[12:15], v[64:79]
    v_mfma_f32_32x32x16_bf16 v[80:95], v[116:119], v[12:15], v[80:95]
Lo_f1:
    s_bitcmp1_b32 s29, 2
    s_cbranch_scc0 Lo_f2
    v_mfma_f32_32x32x16_bf16 v[64:79], v[120:123], v[16:19], v[64:79]
    v_mfma_f32_32x32x16_bf16 v[80:95], v[124:127], v[16:19], v[80:95]
Lo_f2:
    s_bitcmp1_b32 s29, 3
    s_cbranch_scc0 Lo_f3
    v_mfma_f32_32x32x16_bf16 v[64:79], v[128:131], v[20:23], v[64:79]
    v_mfma_f32_32x32x16_bf16 v[80:95], v[132:135], v[20:23], v[80:95]
Lo_f3:
    s_bitcmp1_b32 s29, 4
    s_cbranch_scc0 Lo_f4
    v_mfma_f32_32x32x16_bf16 v[64:79], v[136:139], v[24:27], v[64:79]
    v_mfma_f32_32x32x16_bf16 v[80:95], v[140:143], v[24:27], v[80:95]
Lo_f4:
    s_bitcmp1_b32 s29, 5
    s_cbranch_scc0 Lo_f5
    v_mfma_f32_32x32x16_bf16 v[64:79], v[144:147], v[28:31], v[64:79]
    v_mfma_f32_32x32x16_bf16 v[80:95], v[148:151], v[28:31], v[80:95]
Lo_f5:
    s_bitcmp1_b32 s29, 6
    s_cbranch_scc0 Lo_f6
    v_mfma_f32_32x32x16_bf16 v[64:79], v[152:155], v[32:35], v[64:79]
    v_mfma_f32_32x32x16_bf16 v[80:95], v[156:159], v[32:35], v[80:95]
Lo_f6:
    s_bitcmp1_b32 s29, 7
    s_cbranch_scc0 Lo_f7
    v_mfma_f32_32x32x16_bf16 v[64:79], v[160:163], v[36:39], v[64:79]
    v_mfma_f32_32x32x16_bf16 v[80:95], v[164:167], v[36:39], v[80:95]
Lo_f7:
    s_cmp_eq_u32 s28, 0xff
    s_cbranch_scc1 Lo_rx
    s_mov_b32 s39, 1048576
Lo_r:
    buffer_load_dword v102, v4, s[8:11], s45 offen sc1
    s_waitcnt vmcnt(1) lgkmcnt(0)
    v_cmp_eq_u32 vcc, s7, v7
    s_and_b32 s33, vcc_lo, 0xff
    s_andn2_b32 s29, s33, s28
    s_cbranch_scc1 Lo_w102_t
    s_sleep 3
    s_branch Lo_w102_n
Lo_w102_t:
    s_or_b32 s28, s28, s29
    s_bitcmp1_b32 s29, 0
    s_cbranch_scc0 Lo_w102_l0
    buffer_load_dwordx4 v[8:11], v1, s[8:11], s24 offen offset:0 sc1
Lo_w102_l0:
    s_bitcmp1_b32 s29, 1
    s_cbranch_scc0 Lo_w102_l1
    buffer_load_dwordx4 v[12:15], v1, s[8:11], s24 offen offset:1024 sc1
Lo_w102_l1:
    s_bitcmp1_b32 s29, 2
    s_cbranch_scc0 Lo_w102_l2
    buffer_load_dwordx4 v[16:19], v1, s[8:11], s24 offen offset:2048 sc1
Lo_w102_l2:
    s_bitcmp1_b32 s29, 3
    s_cbranch_scc0 Lo_w102_l3
    buffer_load_dwordx4 v[20:23], v1, s[8:11], s24 offen offset:3072 sc1
Lo_w102_l3:
    s_bitcmp1_b32 s29, 4
    s_cbranch_scc0 Lo_w102_l4
    buffer_load_dwordx4 v[24:27], v1, s[8:11], s25 offen offset:0 sc1
Lo_w102_l4:
    s_bitcmp1_b32 s29, 5
    s_cbranch_scc0 Lo_w102_l5
    buffer_load_dwordx4 v[28:31], v1, s[8:11], s25 offen offset:1024 sc1
Lo_w102_l5:
    s_bitcmp1_b32 s29, 6
    s_cbranch_scc0 Lo_w102_l6
    buffer_load_dwordx4 v[32:35], v1, s[8:11], s25 offen offset:2048 sc1
Lo_w102_l6:
    s_bitcmp1_b32 s29, 7
    s_cbranch_scc0 Lo_w102_l7
    buffer_load_dwordx4 v[36:39], v1, s[8:11], s25 offen offset:3072 sc1
Lo_w102_l7:
    s_waitcnt vmcnt(0) lgkmcnt(0)
    s_bitcmp1_b32 s29, 0
    s_cbranch_scc0 Lo_w102_m0
    v_mfma_f32_32x32x16_bf16 v[64:79], v[104:107], v[8:11], v[64:79]
    v_mfma_f32_32x32x16_bf16 v[80:95], v[108:111], v[8:11], v[80:95]
Lo_w102_m0:
    s_bitcmp1_b32 s29, 1
    s_cbranch_scc0 Lo_w102_m1
    v_mfma_f32_32x32x16_bf16 v[64:79], v[112:115], v[12:15], v[64:79]
    v_mfma_f32_32x32x16_bf16 v[80:95], v[116:119], v[12:15], v[80:95]
Lo_w102_m1:
    s_bitcmp1_b32 s29, 2
    s_cbranch_scc0 Lo_w102_m2
    v_mfma_f32_32x32x16_bf16 v[64:79], v[120:123], v[16:19], v[64:79]
    v_mfma_f32_32x32x16_bf16 v[80:95], v[124:127], v[16:19], v[80:95]
Lo_w102_m2:
    s_bitcmp1_b32 s29, 3
    s_cbranch_scc0 Lo_w102_m3
    v_mfma_f32_32x32x16_bf16 v[64:79], v[128:131], v[20:23], v[64:79]
    v_mfma_f32_32x32x16_bf16 v[80:95], v[132:135], v[20:23], v[80:95]
Lo_w102_m3:
    s_bitcmp1_b32 s29, 4
    s_cbranch_scc0 Lo_w102_m4
    v_mfma_f32_32x32x16_bf16 v[64:79], v[136:139], v[24:27], v[64:79]
    v_mfma_f32_32x32x16_bf16 v[80:95], v[140:143], v[24:27], v[80:95]
Lo_w102_m4:
    s_bitcmp1_b32 s29, 5
    s_cbranch_scc0 Lo_w102_m5
    v_mfma_f32_32x32x16_bf16 v[64:79], v[144:147], v[28:31], v[64:79]
    v_mfma_f32_32x32x16_bf16 v[80:95], v[148:151], v[28:31], v[80:95]
Lo_w102_m5:
    s_bitcmp1_b32 s29, 6
    s_cbranch_scc0 Lo_w102_m6
    v_mfma_f32_32x32x16_bf16 v[64:79], v[152:155], v[32:35], v[64:79]
    v_mfma_f32_32x32x16_bf16 v[80:95], v[156:159], v[32:35], v[80:95]
Lo_w102_m6:
    s_bitcmp1_b32 s29, 7
    s_cbranch_scc0 Lo_w102_m7
    v_mfma_f32_32x32x16_bf16 v[64:79], v[160:163], v[36:39], v[64:79]
    v_mfma_f32_32x32x16_bf16 v[80:95], v[164:167], v[36:39], v[80:95]
Lo_w102_m7:
    s_cmp_eq_u32 s28, 0xff
    s_cbranch_scc1 Lo_rx
Lo_w102_n:
    buffer_load_dword v7, v4, s[8:11], s45 offen sc1
    s_waitcnt vmcnt(1) lgkmcnt(0)
    v_cmp_eq_u32 vcc, s7, v102
    s_and_b32 s33, vcc_lo, 0xff
    s_andn2_b32 s29, s33, s28
    s_cbranch_scc1 Lo_w7_t
    s_sleep 3
    s_branch Lo_w7_n
Lo_w7_t:
    s_or_b32 s28, s28, s29
    s_bitcmp1_b32 s29, 0
    s_cbranch_scc0 Lo_w7_l0
    buffer_load_dwordx4 v[8:11], v1, s[8:11], s24 offen offset:0 sc1
Lo_w7_l0:
    s_bitcmp1_b32 s29, 1
    s_cbranch_scc0 Lo_w7_l1
    buffer_load_dwordx4 v[12:15], v1, s[8:11], s24 offen offset:1024 sc1
Lo_w7_l1:
    s_bitcmp1_b32 s29, 2
    s_cbranch_scc0 Lo_w7_l2
    buffer_load_dwordx4 v[16:19], v1, s[8:11], s24 offen offset:2048 sc1
Lo_w7_l2:
    s_bitcmp1_b32 s29, 3
    s_cbranch_scc0 Lo_w7_l3
    buffer_load_dwordx4 v[20:23], v1, s[8:11], s24 offen offset:3072 sc1
Lo_w7_l3:
    s_bitcmp1_b32 s29, 4
    s_cbranch_scc0 Lo_w7_l4
    buffer_load_dwordx4 v[24:27], v1, s[8:11], s25 offen offset:0 sc1
Lo_w7_l4:
    s_bitcmp1_b32 s29, 5
    s_cbranch_scc0 Lo_w7_l5
    buffer_load_dwordx4 v[28:31], v1, s[8:11], s25 offen offset:1024 sc1
Lo_w7_l5:
    s_bitcmp1_b32 s29, 6
    s_cbranch_scc0 Lo_w7_l6
    buffer_load_dwordx4 v[32:35], v1, s[8:11], s25 offen offset:2048 sc1
Lo_w7_l6:
    s_bitcmp1_b32 s29, 7
    s_cbranch_scc0 Lo_w7_l7
    buffer_load_dwordx4 v[36:39], v1, s[8:11], s25 offen offset:3072 sc1
Lo_w7_l7:
    s_waitcnt vmcnt(0) lgkmcnt(0)
    s_bitcmp1_b32 s29, 0
    s_cbranch_scc0 Lo_w7_m0
    v_mfma_f32_32x32x16_bf16 v[64:79], v[104:107], v[8:11], v[64:79]
    v_mfma_f32_32x32x16_bf16 v[80:95], v[108:111], v[8:11], v[80:95]
Lo_w7_m0:
    s_bitcmp1_b32 s29, 1
    s_cbranch_scc0 Lo_w7_m1
    v_mfma_f32_32x32x16_bf16 v[64:79], v[112:115], v[12:15], v[64:79]
    v_mfma_f32_32x32x16_bf16 v[80:95], v[116:119], v[12:15], v[80:95]
Lo_w7_m1:
    s_bitcmp1_b32 s29, 2
    s_cbranch_scc0 Lo_w7_m2
    v_mfma_f32_32x32x16_bf16 v[64:79], v[120:123], v[16:19], v[64:79]
    v_mfma_f32_32x32x16_bf16 v[80:95], v[124:127], v[16:19], v[80:95]
Lo_w7_m2:
    s_bitcmp1_b32 s29, 3
    s_cbranch_scc0 Lo_w7_m3
    v_mfma_f32_32x32x16_bf16 v[64:79], v[128:131], v[20:23], v[64:79]
    v_mfma_f32_32x32x16_bf16 v[80:95], v[132:135], v[20:23], v[80:95]
Lo_w7_m3:
    s_bitcmp1_b32 s29, 4
    s_cbranch_scc0 Lo_w7_m4
    v_mfma_f32_32x32x16_bf16 v[64:79], v[136:139], v[24:27], v[64:79]
    v_mfma_f32_32x32x16_bf16 v[80:95], v[140:143], v[24:27], v[80:95]
Lo_w7_m4:
    s_bitcmp1_b32 s29, 5
    s_cbranch_scc0 Lo_w7_m5
    v_mfma_f32_32x32x16_bf16 v[64:79], v[144:147], v[28:31], v[64:79]
    v_mfma_f32_32x32x16_bf16 v[80:95], v[148:151], v[28:31], v[80:95]
Lo_w7_m5:
    s_bitcmp1_b32 s29, 6
    s_cbranch_scc0 Lo_w7_m6
    v_mfma_f32_32x32x16_bf16 v[64:79], v[152:155], v[32:35], v[64:79]
    v_mfma_f32_32x32x16_bf16 v[80:95], v[156:159], v[32:35], v[80:95]
Lo_w7_m6:
    s_bitcmp1_b32 s29, 7
    s_cbranch_scc0 Lo_w7_m7
    v_mfma_f32_32x32x16_bf16 v[64:79], v[160:163], v[36:39], v[64:79]
    v_mfma_f32_32x32x16_bf16 v[80:95], v[164:167], v[36:39], v[80:95]
Lo_w7_m7:
    s_cmp_eq_u32 s28, 0xff
    s_cbranch_scc1 Lo_rx
Lo_w7_n:
    s_sub_u32 s39, s39, 16
    s_cbranch_scc0 Lo_r
Lo_rx:
    v_mov_b32 v2, 160036
    s_mov_b32 s39, 65536
Lo_sd:
    ds_read_b32 v3, v2
    s_sub_u32 s39, s39, 1
    s_cbranch_scc1 Lo_sd_x
    s_waitcnt lgkmcnt(0)
    v_readfirstlane_b32 s33, v3
    s_cmp_ge_u32 s33, 8
    s_cbranch_scc1 Lo_sd_x
    s_sleep 1
    s_branch Lo_sd
Lo_sd_x:
    s_waitcnt lgkmcnt(0)
Lo_sdx:
    s_nop 10
    ds_write_b128 v96, v[64:67] offset:0
    ds_write_b128 v97, v[68:71] offset:0
    ds_write_b128 v98, v[72:75] offset:0
    ds_write_b128 v99, v[76:79] offset:0
    ds_write_b128 v96, v[80:83] offset:4096
    ds_write_b128 v97, v[84:87] offset:4096
    ds_write_b128 v98, v[88:91] offset:4096
    ds_write_b128 v99, v[92:95] offset:4096
    s_waitcnt lgkmcnt(0)
    v_mov_b32 v2, 160044
    v_mov_b32 v3, 1
    s_mov_b64 exec, 1
    ds_add_u32 v2, v3
    s_mov_b64 exec, -1
    s_mov_b32 s39, 65536
Lo_fe:
    ds_read_b32 v3, v2
    s_sub_u32 s39, s39, 1
    s_cbranch_scc1 Lo_fe_x
    s_waitcnt lgkmcnt(0)
    v_readfirstlane_b32 s33, v3
    s_cmp_ge_u32 s33, 8
    s_cbranch_scc0 Lo_fe
Lo_fe_x:
    s_waitcnt lgkmcnt(0)
    ds_read_b128 v[8:11], v100 offset:0
    ds_read_b128 v[12:15], v100 offset:1024
    ds_read_b128 v[16:19], v100 offset:16384
    ds_read_b128 v[20:23], v100 offset:17408
    ds_read_b128 v[24:27], v100 offset:32768
    ds_read_b128 v[28:31], v100 offset:33792
    ds_read_b128 v[32:35], v100 offset:49152
    ds_read_b128 v[36:39], v100 offset:50176
    s_waitcnt lgkmcnt(4)
    v_pk_add_f32 v[8:9], v[8:9], v[16:17] op_sel:[0,0] op_sel_hi:[1,1]
    v_pk_add_f32 v[10:11], v[10:11], v[18:19] op_sel:[0,0] op_sel_hi:[1,1]
    v_pk_add_f32 v[12:13], v[12:13], v[20:21] op_sel:[0,0] op_sel_hi:[1,1]
    v_pk_add_f32 v[14:15], v[14:15], v[22:23] op_sel:[0,0] op_sel_hi:[1,1]
    s_waitcnt lgkmcnt(0)
    v_pk_add_f32 v[24:25], v[24:25], v[32:33] op_sel:[0,0] op_sel_hi:[1,1]
    v_pk_add_f32 v[26:27], v[26:27], v[34:35] op_sel:[0,0] op_sel_hi:[1,1]
    v_pk_add_f32 v[28:29], v[28:29], v[36:37] op_sel:[0,0] op_sel_hi:[1,1]
    v_pk_add_f32 v[30:31], v[30:31], v[38:39] op_sel:[0,0] op_sel_hi:[1,1]
    v_pk_add_f32 v[8:9], v[8:9], v[24:25] op_sel:[0,0] op_sel_hi:[1,1]
    v_pk_add_f32 v[10:11], v[10:11], v[26:27] op_sel:[0,0] op_sel_hi:[1,1]
    buffer_store_dwordx4 v[8:11], v101, s[16:19], s26 offen sc1
    v_pk_add_f32 v[12:13], v[12:13], v[28:29] op_sel:[0,0] op_sel_hi:[1,1]
    v_pk_add_f32 v[14:15], v[14:15], v[30:31] op_sel:[0,0] op_sel_hi:[1,1]
    buffer_store_dwordx4 v[12:15], v101, s[16:19], s27 offen sc1
    s_or_b32 s33, s2, s20
    s_cmp_eq_u32 s33, 0
    s_cbranch_scc0 Lo_e
    v_mov_b32 v4, s7
    v_mov_b32 v5, 13119488
    s_mov_b64 exec, 1
    buffer_store_dword v4, v5, s[8:11], 0 offen sc1
Lo_e:
    s_endpgm
La_slow:
    s_lshl_b32 s43, s21, 16
    s_lshl_b32 s33, s38, 10
    s_add_u32 s33, s33, s43
    buffer_load_dwordx4 v[160:163], v1, s[8:11], s33 offen sc1
    s_add_u32 s24, s43, 2097152
    s_add_u32 s26, s43, 4194304
    v_mov_b32 v7, 0xff800000
    s_mov_b32 s29, 0
La_mx:
    s_add_u32 s33, s24, s29
    buffer_load_dwordx4 v[8:11], v1, s[8:11], s33 offen sc1
    s_waitcnt vmcnt(0)
    v_mfma_f32_32x32x16_bf16 v[104:119], v[8:11], v[160:163], 0
    s_nop 15
    v_max3_f32 v7, v104, v105, v7
    v_max3_f32 v7, v106, v107, v7
    v_max3_f32 v7, v108, v109, v7
    v_max3_f32 v7, v110, v111, v7
    v_max3_f32 v7, v112, v113, v7
    v_max3_f32 v7, v114, v115, v7
    v_max3_f32 v7, v116, v117, v7
    v_max3_f32 v7, v118, v119, v7
    s_add_u32 s29, s29, 1024
    s_cmp_lt_u32 s29, 65536
    s_cbranch_scc1 La_mx
    v_mov_b32 v4, v7
    s_nop 1
    v_permlane32_swap_b32 v4, v7
    s_nop 1
    v_max_f32 v7, v4, v7
    v_sub_f32 v7, 0, v7
    v_mov_b32 v120, v7
    v_mov_b32 v121, v7
    v_mov_b32 v122, v7
    v_mov_b32 v123, v7
    v_mov_b32 v124, v7
    v_mov_b32 v125, v7
    v_mov_b32 v126, v7
    v_mov_b32 v127, v7
    v_mov_b32 v128, v7
    v_mov_b32 v129, v7
    v_mov_b32 v130, v7
    v_mov_b32 v131, v7
    v_mov_b32 v132, v7
    v_mov_b32 v133, v7
    v_mov_b32 v134, v7
    v_mov_b32 v135, v7
    v_mov_b32 v144, 0
    v_mov_b32 v145, 0
    v_mov_b32 v146, 0
    v_mov_b32 v147, 0
    v_mov_b32 v148, 0
    v_mov_b32 v149, 0
    v_mov_b32 v150, 0
    v_mov_b32 v151, 0
    v_mov_b32 v152, 0
    v_mov_b32 v153, 0
    v_mov_b32 v154, 0
    v_mov_b32 v155, 0
    v_mov_b32 v156, 0
    v_mov_b32 v157, 0
    v_mov_b32 v158, 0
    v_mov_b32 v159, 0
    s_mov_b32 s29, 0
La_sl:
    s_add_u32 s33, s24, s29
    buffer_load_dwordx4 v[8:11], v1, s[8:11], s33 offen sc1
    s_add_u32 s33, s26, s29
    s_mov_b64 exec, s[36:37]
    buffer_load_dwordx4 v[40:43], v2, s[8:11], s33 offen sc1
    buffer_load_dwordx4 v[44:47], v2, s[8:11], s33 offen offset:512 sc1
    s_mov_b64 exec, -1
    s_waitcnt vmcnt(0)
    v_mfma_f32_32x32x16_bf16 v[104:119], v[8:11], v[160:163], v[120:135]
    s_nop 15
    v_exp_f32 v104, v104
    v_exp_f32 v105, v105
    v_exp_f32 v106, v106
    v_exp_f32 v107, v107
    v_exp_f32 v108, v108
    v_exp_f32 v109, v109
    v_exp_f32 v110, v110
    v_exp_f32 v111, v111
    v_exp_f32 v112, v112
    v_exp_f32 v113, v113
    v_exp_f32 v114, v114
    v_exp_f32 v115, v115
    v_exp_f32 v116, v116
    v_exp_f32 v117, v117
    v_exp_f32 v118, v118
    v_exp_f32 v119, v119
    s_nop 1
    v_smfmac_f32_32x32x32_bf16 v[144:159], v[40:43], v[104:111], v143
    v_smfmac_f32_32x32x32_bf16 v[144:159], v[44:47], v[112:119], v143
    s_add_u32 s29, s29, 1024
    s_cmp_lt_u32 s29, 65536
    s_cbranch_scc1 La_sl
    s_nop 15
    v_rcp_f32 v7, v152
    s_nop 0
    v_mul_f32 v144, v7, v144
    v_mul_f32 v145, v7, v145
    v_mul_f32 v146, v7, v146
    v_mul_f32 v147, v7, v147
    v_mul_f32 v148, v7, v148
    v_mul_f32 v149, v7, v149
    v_mul_f32 v150, v7, v150
    v_mul_f32 v151, v7, v151
    v_cvt_pk_bf16_f32 v136, v144, v145
    v_cvt_pk_bf16_f32 v137, v146, v147
    v_cvt_pk_bf16_f32 v138, v148, v149
    v_cvt_pk_bf16_f32 v139, v150, v151
    buffer_store_dwordx4 v[136:139], v1, s[8:11], s34 offen sc1
    s_branch La_st
L_i0:
    s_mov_b32 s41, 9
L_i2:
    s_barrier
    s_sub_u32 s41, s41, 1
    s_cmp_lg_u32 s41, 0
    s_cbranch_scc1 L_i2
    s_branch L_i1
L_last:
.section .rodata,"a"
.p2align 6
.amdhsa_kernel concat_heads__ssm_conv_s5__mha_block__prompt_kernel
  .amdhsa_next_free_vgpr 168
  .amdhsa_next_free_sgpr 102
  .amdhsa_accum_offset 168
  .amdhsa_group_segment_fixed_size 0
  .amdhsa_kernarg_size 120
  .amdhsa_user_sgpr_count 2
  .amdhsa_user_sgpr_kernarg_segment_ptr 1
  .amdhsa_system_sgpr_workgroup_id_x 1
.end_amdhsa_kernel
```
